```python
import torch

def _softmax(x, axis=-1):
    return torch.softmax(x, dim=axis)
def _gelu(x):
    return torch.nn.functional.gelu(x, approximate="tanh")
def _silu(x):
    return torch.nn.functional.silu(x)
def _sigmoid(x):
    return torch.sigmoid(x)
def _layernorm(x, axis=-1, eps=1e-5):
    m = x.mean(dim=axis, keepdim=True)
    v = x.var(dim=axis, keepdim=True, unbiased=False)
    return (x - m) / torch.sqrt(v + eps)
def _scatter_add(tgt, idx, src, axis=0):
    return tgt.clone().index_add_(axis, idx, src)
def _segment_sum(src, seg, n):
    out = torch.zeros((n,) + src.shape[1:], dtype=src.dtype)
    return out.index_add_(0, seg, src)
def _pad(x, pw):
    flat = tuple(v for pair in reversed(pw) for v in pair)
    return torch.nn.functional.pad(x, flat)

kernel_name = 'gated_mix__linear_kernel_hedgehog__dense_activation_relu__prompt'

def setup_inputs():

    _w = (lambda a: (lambda t: t.to(torch.bfloat16) if t.is_floating_point() else t)(torch.as_tensor(a)))
    def _A_setup():
        B, S, D, H = 1, 2048, 512, 32
        Dh = D // H
        return {
            "x": _w((lambda *s: torch.randn(*s, dtype=torch.bfloat16) * 0.05)(B, S, D)),
            "wqkv": _w((lambda *s: torch.randn(*s, dtype=torch.bfloat16) * 0.8)(D, 3 * D)),
            "w_phi": _w((lambda *s: torch.randn(*s, dtype=torch.bfloat16) * 0.8)(H, Dh, Dh) * (Dh ** -0.5)),
            "wo": _w((lambda *s: torch.randn(*s, dtype=torch.bfloat16) * 0.2)(D, D)),
        }
    _A_in = _A_setup()

    def _B_setup():
        B, S, D, Dff = 1, 2048, 512, 1792
        return {
            "x": _w((lambda *s: torch.randn(*s, dtype=torch.bfloat16) * 0.05)(B, S, D)),
            "w1": _w((lambda *s: torch.randn(*s, dtype=torch.bfloat16) * 0.05)(D, Dff)),
            "w2": _w((lambda *s: torch.randn(*s, dtype=torch.bfloat16) * 0.05)(Dff, D)),
        }
    _B_in = _B_setup()

    return {
        "A_x": _A_in["x"],
        "A_wqkv": _A_in["wqkv"],
        "A_w_phi": _A_in["w_phi"],
        "A_wo": _A_in["wo"],
        "B_x": _B_in["x"],
        "B_w1": _B_in["w1"],
        "B_w2": _B_in["w2"],
        "gate_w": _w((lambda *s: torch.randn(*s, dtype=torch.bfloat16) * 0.05)(512) * 16.0),
    }

def reference(A_x, A_wqkv, A_w_phi, A_wo, B_x, B_w1, B_w2, gate_w):
    def _A_ref(x, wqkv, w_phi, wo):
        B, S, D = x.shape
        H = 32; Dh = D // H
        qkv = (lambda x, *d: x.permute(*d))((x @ wqkv).reshape(B, S, 3, H, Dh), 2, 0, 3, 1, 4)
        q, k, v = qkv[0], qkv[1], qkv[2]
        pq = torch.einsum("bhsd,hdf->bhsf", q, w_phi)
        pk = torch.einsum("bhsd,hdf->bhsf", k, w_phi)
        phi_q = torch.concatenate([_softmax(pq, axis=-1), _softmax(-pq, axis=-1)], axis=-1)
        phi_k = torch.concatenate([_softmax(pk, axis=-1), _softmax(-pk, axis=-1)], axis=-1)
        kv = torch.einsum("bhsf,bhsd->bhfd", phi_k, v)
        z  = torch.einsum("bhsf->bhf", phi_k)
        num = torch.einsum("bhqf,bhfd->bhqd", phi_q, kv)
        den = torch.einsum("bhqf,bhf->bhq", phi_q, z)[..., None] + 1e-6
        o = num / den
        return (lambda x, *d: x.permute(*d))(o, 0, 2, 1, 3).reshape(B, S, D) @ wo

    def _B_ref(x, w1, w2):
        h = torch.einsum("bsd,df->bsf", x, w1)
        zero = torch.zeros_like(h)
        h = torch.maximum(h, zero)
        return torch.einsum("bsf,fd->bsd", h, w2)

    x = A_x
    g = _sigmoid((x * gate_w).sum(-1, keepdims=True))
    a = _A_ref(x, A_wqkv, A_w_phi, A_wo)
    b = _B_ref(x, B_w1, B_w2)
    return g * a + (1 - g) * b
```

```asm
; @launch grid=(256,1,1) block=(512,1,1) lds=163840
.amdgcn_target "amdgcn-amd-amdhsa--gfx950"
.text
.globl gated_mix__linear_kernel_hedgehog__dense_activation_relu__prompt_kernel
.p2align 8
.type gated_mix__linear_kernel_hedgehog__dense_activation_relu__prompt_kernel,@function
gated_mix__linear_kernel_hedgehog__dense_activation_relu__prompt_kernel:
    s_cmp_ge_u32 s2, 256
    s_cbranch_scc1 F_END
    s_load_dwordx2 s[28:29], s[0:1], 0
    s_load_dwordx2 s[32:33], s[0:1], 8
    s_load_dwordx2 s[4:5], s[0:1], 40
    s_and_b32 s81, s2, 7
    s_lshr_b32 s82, s2, 3
    s_getpc_b64 s[12:13]
F_PCE:
    s_sub_u32 s12, s12, F_PCE - gated_mix__linear_kernel_hedgehog__dense_activation_relu__prompt_kernel
    s_subb_u32 s13, s13, 0
    s_mov_b32 s14, F_CODE_END - gated_mix__linear_kernel_hedgehog__dense_activation_relu__prompt_kernel
    s_mov_b32 s15, 0x00020000
    s_lshl_b32 s3, s82, 10
    v_lshlrev_b32 v4, 6, v0
    v_add_u32 v4, s3, v4
    v_cmp_gt_u32 vcc, 16, v0
    s_nop 0
    s_and_saveexec_b64 s[26:27], vcc
    s_cbranch_execz F_PCF
    buffer_load_dword v14, v4, s[12:15], 0 offen
F_PCF:
    s_mov_b64 exec, -1
    v_lshrrev_b32 v1, 6, v0
    v_and_b32 v0, 63, v0
    v_readfirstlane_b32 s60, v1
    s_lshr_b32 s3, s81, 1
    s_lshl_b32 s61, s3, 2
    s_lshr_b32 s3, s82, 3
    s_add_u32 s61, s61, s3
    s_and_b32 s26, s81, 1
    s_lshl_b32 s62, s26, 2
    s_and_b32 s3, s82, 3
    s_add_u32 s62, s62, s3
    s_mov_b32 s30, 2097152
    s_mov_b32 s31, 0x00020000
    s_mov_b32 s34, 1572864
    s_mov_b32 s35, 0x00020000
    s_mov_b32 s6, 1835008
    s_mov_b32 s7, 0x00020000
    s_lshl_b32 s3, s26, 2
    s_and_b32 s27, s81, 6
    s_add_u32 s3, s3, s27
    s_and_b32 s76, s3, 7
    s_min_u32 s76, s76, 6
    s_mov_b32 s88, s76
    v_lshrrev_b32 v4, 3, v0
    v_lshrrev_b32 v5, 4, v0
    v_and_b32 v6, 7, v0
    s_and_b32 s87, s60, 1
    s_lshl_b32 s3, s87, 2
    s_lshl_b32 s63, s60, 10
    v_add_u32 v5, s3, v5
    v_xor_b32 v5, v5, v6
    v_lshlrev_b32 v5, 4, v5
    v_lshl_add_u32 v2, v4, 10, v5
    s_lshl_b32 s64, s61, 17
    s_lshl_b32 s3, s60, 13
    s_add_u32 s64, s64, s3
    s_add_u32 s65, s64, 65536
    v_bfe_u32 v5, v0, 4, 1
    v_lshlrev_b32 v5, 2, v5
    v_xor_b32 v5, v5, v6
    v_lshlrev_b32 v5, 4, v5
    v_mul_u32_u24 v3, 3072, v4
    v_add_u32 v3, v3, v5
    s_lshl_b32 s26, s60, 3
    s_mul_i32 s3, s26, 3072
    s_lshl_b32 s27, s62, 7
    s_add_u32 s67, s3, s27
    s_bitcmp1_b32 s82, 2
    s_cbranch_scc1 F_HQ0
    s_add_u32 s66, s67, 1024
    s_add_u32 s67, s67, 2048
    s_waitcnt lgkmcnt(0)
    s_add_u32 s88, s88, 1
    s_mov_b32 s3, s88
    s_lshl_b32 s16, s3, 7
    s_mul_i32 s18, s3, 196608
    s_add_u32 m0, s63, 0
    s_nop 0
    buffer_load_dwordx4 v2, s[28:31], s64 offen lds
    s_add_u32 s64, s64, s16
    s_add_u32 m0, s63, 8192
    s_nop 0
    buffer_load_dwordx4 v2, s[28:31], s65 offen lds
    s_add_u32 s65, s65, s16
    s_add_u32 m0, s63, 49152
    s_nop 0
    buffer_load_dwordx4 v3, s[32:35], s66 offen lds
    s_add_u32 s66, s66, s18
    s_add_u32 m0, s63, 57344
    s_nop 0
    buffer_load_dwordx4 v3, s[32:35], s67 offen lds
    s_add_u32 s67, s67, s18
    s_load_dwordx2 s[36:37], s[0:1], 80
    s_load_dwordx2 s[40:41], s[0:1], 16
    s_load_dwordx2 s[44:45], s[0:1], 48
    s_load_dwordx2 s[48:49], s[0:1], 24
    s_load_dwordx2 s[52:53], s[0:1], 64
    s_load_dwordx2 s[56:57], s[0:1], 72
    s_load_dwordx2 s[8:9], s[0:1], 56
    s_branch F_KV
F_HQ0:
    v_add_u32 v4, 0, v0
    v_mul_u32_u24 v5, 2731, v4
    v_lshrrev_b32 v5, 16, v5
    v_mul_u32_u24 v6, 24, v5
    v_sub_u32 v4, v4, v6
    v_lshlrev_b32 v6, 1, v5
    v_and_b32 v6, 4, v6
    v_xor_b32 v4, v4, v6
    v_lshlrev_b32 v4, 4, v4
    v_mul_u32_u24 v5, 3584, v5
    v_add_u32 v128, v5, v4
    v_add_u32 v4, 64, v0
    v_mul_u32_u24 v5, 2731, v4
    v_lshrrev_b32 v5, 16, v5
    v_mul_u32_u24 v6, 24, v5
    v_sub_u32 v4, v4, v6
    v_lshlrev_b32 v6, 1, v5
    v_and_b32 v6, 4, v6
    v_xor_b32 v4, v4, v6
    v_lshlrev_b32 v4, 4, v4
    v_mul_u32_u24 v5, 3584, v5
    v_add_u32 v129, v5, v4
    v_add_u32 v4, 128, v0
    v_mul_u32_u24 v5, 2731, v4
    v_lshrrev_b32 v5, 16, v5
    v_mul_u32_u24 v6, 24, v5
    v_sub_u32 v4, v4, v6
    v_lshlrev_b32 v6, 1, v5
    v_and_b32 v6, 4, v6
    v_xor_b32 v4, v4, v6
    v_lshlrev_b32 v4, 4, v4
    v_mul_u32_u24 v5, 3584, v5
    v_add_u32 v130, v5, v4
    s_mul_i32 s3, s26, 3584
    s_mul_i32 s27, s62, 384
    s_add_u32 s66, s3, s27
    s_lshr_b32 s27, s62, 1
    s_lshl_b32 s27, s27, 7
    s_add_u32 s66, s66, s27
    s_lshl_b32 s70, s60, 12
    s_waitcnt lgkmcnt(0)
    s_add_u32 s88, s88, 1
    s_mov_b32 s3, s88
    s_lshl_b32 s16, s3, 7
    s_mul_i32 s18, s3, 196608
    s_mul_i32 s17, s3, 229376
    s_add_u32 m0, s63, 0
    s_nop 0
    buffer_load_dwordx4 v2, s[28:31], s64 offen lds
    s_add_u32 s64, s64, s16
    s_add_u32 m0, s63, 8192
    s_nop 0
    buffer_load_dwordx4 v2, s[28:31], s65 offen lds
    s_add_u32 s65, s65, s16
    s_add_u32 m0, s70, 49152
    s_nop 0
    buffer_load_dwordx4 v128, s[4:7], s66 offen lds
    s_add_u32 m0, s70, 50176
    s_nop 0
    buffer_load_dwordx4 v129, s[4:7], s66 offen lds
    s_add_u32 m0, s70, 51200
    s_nop 0
    buffer_load_dwordx4 v130, s[4:7], s66 offen lds
    s_add_u32 s66, s66, s17
    s_add_u32 m0, s70, 52224
    s_nop 0
    buffer_load_dwordx4 v3, s[32:35], s67 offen lds
    s_add_u32 s67, s67, s18
    s_load_dwordx2 s[36:37], s[0:1], 80
    s_load_dwordx2 s[40:41], s[0:1], 16
    s_load_dwordx2 s[44:45], s[0:1], 48
    s_load_dwordx2 s[48:49], s[0:1], 24
    s_load_dwordx2 s[52:53], s[0:1], 64
    s_load_dwordx2 s[56:57], s[0:1], 72
    s_load_dwordx2 s[8:9], s[0:1], 56
    s_mov_b32 s38, 16777216
    s_mov_b32 s39, 0x00020000
    s_mov_b32 s42, 16384
    s_mov_b32 s43, 0x00020000
    s_mov_b32 s46, 1835008
    s_mov_b32 s47, 0x00020000
    s_mov_b32 s50, 524288
    s_mov_b32 s51, 0x00020000
    s_mov_b32 s54, 2097152
    s_mov_b32 s55, 0x00020000
    s_mov_b32 s58, 256
    s_mov_b32 s59, 0x00020000
    s_mov_b32 s10, 1024
    s_mov_b32 s11, 0x00020000
    s_lshl_b32 s79, s81, 2
    s_lshr_b32 s3, s82, 3
    s_add_u32 s79, s79, s3
    s_add_u32 s80, s82, 1
    s_and_b32 s80, s80, 3
    s_lshr_b32 s3, s82, 1
    s_and_b32 s3, s3, 4
    s_cmp_eq_u32 s80, 3
    s_cselect_b32 s3, 0, s3
    s_and_b32 s26, s82, 4
    s_xor_b32 s3, s3, s26
    s_add_u32 s80, s80, s3
    s_and_b32 s83, s60, 3
    s_lshr_b32 s84, s60, 2
    s_mov_b32 s74, 1069066811
    s_mov_b32 s75, 1069066811
    v_and_b32 v8, 31, v0
    v_lshrrev_b32 v9, 5, v0
    v_bfe_u32 v10, v0, 2, 2
    v_bfe_u32 v4, v0, 4, 1
    v_and_b32 v5, 3, v0
    v_lshlrev_b32 v5, 3, v5
    v_lshl_add_u32 v11, v4, 5, v5
    v_lshlrev_b32 v12, 4, v0
    v_mov_b32 v7, 0
    v_lshrrev_b32 v5, 3, v0
    v_lshlrev_b32 v4, 2, v4
    v_and_b32 v6, 7, v0
    v_xor_b32 v4, v4, v6
    v_lshlrev_b32 v4, 4, v4
    v_lshl_add_u32 v15, v5, 10, v4
    s_lshl_b32 s26, s80, 7
    s_lshl_b32 s3, s84, 13
    s_add_u32 s26, s26, s3
    s_mul_i32 s3, s83, 458752
    s_add_u32 s23, s26, s3
    s_lshl_b32 s3, s83, 17
    s_add_u32 s25, s26, s3
    s_lshr_b32 s100, s82, 3
    s_mov_b32 s100, 0
    s_mul_i32 s3, s100, 114688
    s_add_u32 s23, s23, s3
    s_sub_u32 s101, s23, 458752
    s_lshl_b32 s24, s83, 11
    s_lshl_b32 s3, s84, 10
    s_add_u32 s24, s24, s3
    v_lshlrev_b32 v4, 2, v0
    v_add_u32 v4, 158720, v4
    ds_write_b32 v4, v7
    v_mov_b32 v22, 0
    s_lshl_b32 s77, s61, 11
    s_lshl_b32 s3, s62, 7
    s_add_u32 s77, s77, s3
    s_add_u32 s77, s77, 14761984
    s_lshl_b32 s78, s61, 10
    s_add_u32 s78, s78, s3
    s_add_u32 s78, s78, 14794752
    s_lshl_b32 s22, s62, 11
    s_add_u32 s22, s22, 14745600
    s_lshl_b32 s3, s87, 13
    v_bfe_u32 v4, v8, 1, 3
    v_lshlrev_b32 v5, 7, v8
    v_add_u32 v5, s3, v5
    v_add_u32 v6, 0, v9
    v_xor_b32 v6, v6, v4
    v_lshl_add_u32 v16, v6, 4, v5
    v_add_u32 v6, 2, v9
    v_xor_b32 v6, v6, v4
    v_lshl_add_u32 v17, v6, 4, v5
    v_add_u32 v6, 4, v9
    v_xor_b32 v6, v6, v4
    v_lshl_add_u32 v18, v6, 4, v5
    v_add_u32 v6, 6, v9
    v_xor_b32 v6, v6, v4
    v_lshl_add_u32 v19, v6, 4, v5
    s_lshr_b32 s71, s60, 1
    s_cmp_eq_u32 s71, 3
    s_movk_i32 s3, 384
    s_cselect_b32 s26, 128, s3
    s_lshl_b32 s27, s71, 7
    s_cmp_eq_u32 s71, 3
    s_cselect_b32 s27, 3072, s27
    s_add_u32 s27, s27, 49152
    v_mul_u32_u24 v4, s26, v10
    v_lshl_add_u32 v4, v9, 12, v4
    v_add_u32 v4, v4, v11
    v_add_u32 v4, s27, v4
    v_lshrrev_b32 v5, 1, v10
    s_lshl_b32 s26, s26, 2
    v_xor_b32 v6, 0, v5
    v_lshl_add_u32 v132, v6, 6, v4
    v_add_u32 v133, s26, v132
    v_xor_b32 v6, 1, v5
    v_lshl_add_u32 v134, v6, 6, v4
    v_add_u32 v135, s26, v134
    v_add_u32 v136, 65536, v132
    v_add_u32 v137, 65536, v133
    v_add_u32 v138, 65536, v134
    v_add_u32 v139, 65536, v135
    s_lshl_b32 s3, s61, 1
    s_add_u32 s3, s3, s87
    s_mul_i32 s72, s3, 295040
    s_mul_i32 s3, s62, 24576
    s_add_u32 s72, s72, s3
    s_lshr_b32 s3, s62, 1
    s_lshl_b32 s3, s3, 13
    s_add_u32 s72, s72, s3
    s_lshl_b32 s3, s71, 13
    s_add_u32 s72, s72, s3
    s_add_u32 s73, s72, 4096
    s_add_u32 s88, s88, 1
    s_cmp_eq_u32 s88, 8
    s_cselect_b32 s3, -6, 1
    s_lshl_b32 s16, s3, 7
    s_mul_i32 s18, s3, 196608
    s_mul_i32 s17, s3, 229376
    s_add_u32 m0, s63, 16384
    s_nop 0
    buffer_load_dwordx4 v2, s[28:31], s64 offen lds
    s_add_u32 s64, s64, s16
    s_add_u32 m0, s63, 24576
    s_nop 0
    buffer_load_dwordx4 v2, s[28:31], s65 offen lds
    s_add_u32 s65, s65, s16
    s_add_u32 m0, s70, 81920
    s_nop 0
    buffer_load_dwordx4 v128, s[4:7], s66 offen lds
    s_add_u32 m0, s70, 82944
    s_nop 0
    buffer_load_dwordx4 v129, s[4:7], s66 offen lds
    s_add_u32 m0, s70, 83968
    s_nop 0
    buffer_load_dwordx4 v130, s[4:7], s66 offen lds
    s_add_u32 s66, s66, s17
    s_add_u32 m0, s70, 84992
    s_nop 0
    buffer_load_dwordx4 v3, s[32:35], s67 offen lds
    s_add_u32 s67, s67, s18
    s_waitcnt vmcnt(6) lgkmcnt(0)
    s_barrier
    ds_read_b128 v[176:179], v16 offset:0
    ds_read_b64_tr_b16 v[184:185], v132 offset:0
    ds_read_b64_tr_b16 v[186:187], v133 offset:0
    ds_read_b128 v[180:183], v16 offset:4096
    ds_read_b64_tr_b16 v[188:189], v134 offset:0
    ds_read_b64_tr_b16 v[190:191], v135 offset:0
    ds_read_b128 v[192:195], v17 offset:0
    ds_read_b64_tr_b16 v[200:201], v132 offset:8192
    ds_read_b64_tr_b16 v[202:203], v133 offset:8192
    ds_read_b128 v[196:199], v17 offset:4096
    ds_read_b64_tr_b16 v[204:205], v134 offset:8192
    ds_read_b64_tr_b16 v[206:207], v135 offset:8192
    s_waitcnt lgkmcnt(6)
    v_mfma_f32_32x32x16_bf16 v[64:79], v[184:187], v[176:179], 0
    ds_read_b128 v[208:211], v18 offset:0
    ds_read_b64_tr_b16 v[216:217], v132 offset:16384
    ds_read_b64_tr_b16 v[218:219], v133 offset:16384
    v_mfma_f32_32x32x16_bf16 v[80:95], v[184:187], v[180:183], 0
    ds_read_b128 v[212:215], v18 offset:4096
    ds_read_b64_tr_b16 v[220:221], v134 offset:16384
    ds_read_b64_tr_b16 v[222:223], v135 offset:16384
    v_mfma_f32_32x32x16_bf16 v[96:111], v[188:191], v[176:179], 0
    ds_read_b128 v[224:227], v19 offset:0
    ds_read_b64_tr_b16 v[232:233], v132 offset:24576
    ds_read_b64_tr_b16 v[234:235], v133 offset:24576
    s_add_u32 s88, s88, 1
    s_cmp_eq_u32 s88, 8
    s_cselect_b32 s3, -6, 1
    s_lshl_b32 s16, s3, 7
    s_mul_i32 s18, s3, 196608
    s_mul_i32 s17, s3, 229376
    s_add_u32 m0, s63, 32768
    s_nop 0
    buffer_load_dwordx4 v2, s[28:31], s64 offen lds
    s_add_u32 s64, s64, s16
    v_mfma_f32_32x32x16_bf16 v[112:127], v[188:191], v[180:183], 0
    ds_read_b128 v[228:231], v19 offset:4096
    ds_read_b64_tr_b16 v[236:237], v134 offset:24576
    ds_read_b64_tr_b16 v[238:239], v135 offset:24576
    s_add_u32 m0, s63, 40960
    s_nop 0
    buffer_load_dwordx4 v2, s[28:31], s65 offen lds
    s_add_u32 s65, s65, s16
    s_waitcnt lgkmcnt(12)
    v_mfma_f32_32x32x16_bf16 v[64:79], v[200:203], v[192:195], v[64:79]
    s_add_u32 m0, s70, 114688
    s_nop 0
    buffer_load_dwordx4 v128, s[4:7], s66 offen lds
    v_mfma_f32_32x32x16_bf16 v[80:95], v[200:203], v[196:199], v[80:95]
    s_add_u32 m0, s70, 115712
    s_nop 0
    buffer_load_dwordx4 v129, s[4:7], s66 offen lds
    v_mfma_f32_32x32x16_bf16 v[96:111], v[204:207], v[192:195], v[96:111]
    v_mfma_f32_32x32x16_bf16 v[112:127], v[204:207], v[196:199], v[112:127]
    s_waitcnt lgkmcnt(6)
    v_mfma_f32_32x32x16_bf16 v[64:79], v[216:219], v[208:211], v[64:79]
    s_waitcnt vmcnt(4) lgkmcnt(0)
    s_barrier
    v_mfma_f32_32x32x16_bf16 v[80:95], v[216:219], v[212:215], v[80:95]
    ds_read_b128 v[240:243], v16 offset:16384
    ds_read_b64_tr_b16 v[248:249], v132 offset:32768
    v_mfma_f32_32x32x16_bf16 v[96:111], v[220:223], v[208:211], v[96:111]
    ds_read_b64_tr_b16 v[250:251], v133 offset:32768
    ds_read_b128 v[244:247], v16 offset:20480
    s_add_u32 m0, s70, 116736
    s_nop 0
    buffer_load_dwordx4 v130, s[4:7], s66 offen lds
    s_add_u32 s66, s66, s17
    v_mfma_f32_32x32x16_bf16 v[112:127], v[220:223], v[212:215], v[112:127]
    ds_read_b64_tr_b16 v[252:253], v134 offset:32768
    ds_read_b64_tr_b16 v[254:255], v135 offset:32768
    s_add_u32 m0, s70, 117760
    s_nop 0
    buffer_load_dwordx4 v3, s[32:35], s67 offen lds
    s_add_u32 s67, s67, s18
    v_mfma_f32_32x32x16_bf16 v[64:79], v[232:235], v[224:227], v[64:79]
    ds_read_b128 v[144:147], v17 offset:16384
    ds_read_b64_tr_b16 v[152:153], v132 offset:40960
    v_mfma_f32_32x32x16_bf16 v[80:95], v[232:235], v[228:231], v[80:95]
    ds_read_b64_tr_b16 v[154:155], v133 offset:40960
    ds_read_b128 v[148:151], v17 offset:20480
    v_mfma_f32_32x32x16_bf16 v[96:111], v[236:239], v[224:227], v[96:111]
    ds_read_b64_tr_b16 v[156:157], v134 offset:40960
    ds_read_b64_tr_b16 v[158:159], v135 offset:40960
    s_add_u32 s88, s88, 1
    s_cmp_eq_u32 s88, 8
    s_cselect_b32 s3, -6, 1
    s_lshl_b32 s16, s3, 7
    s_mul_i32 s18, s3, 196608
    s_mul_i32 s17, s3, 229376
    s_add_u32 m0, s63, 0
    s_nop 0
    buffer_load_dwordx4 v2, s[28:31], s64 offen lds
    s_add_u32 s64, s64, s16
    v_mfma_f32_32x32x16_bf16 v[112:127], v[236:239], v[228:231], v[112:127]
    s_add_u32 m0, s63, 8192
    s_nop 0
    buffer_load_dwordx4 v2, s[28:31], s65 offen lds
    s_add_u32 s65, s65, s16
    s_waitcnt lgkmcnt(6)
    v_mfma_f32_32x32x16_bf16 v[64:79], v[248:251], v[240:243], v[64:79]
    ds_read_b128 v[176:179], v18 offset:16384
    ds_read_b64_tr_b16 v[184:185], v132 offset:49152
    v_mfma_f32_32x32x16_bf16 v[80:95], v[248:251], v[244:247], v[80:95]
    ds_read_b64_tr_b16 v[186:187], v133 offset:49152
    ds_read_b128 v[180:183], v18 offset:20480
    v_mfma_f32_32x32x16_bf16 v[96:111], v[252:255], v[240:243], v[96:111]
    ds_read_b64_tr_b16 v[188:189], v134 offset:49152
    ds_read_b64_tr_b16 v[190:191], v135 offset:49152
    s_add_u32 m0, s70, 49152
    s_nop 0
    buffer_load_dwordx4 v128, s[4:7], s66 offen lds
    v_mfma_f32_32x32x16_bf16 v[112:127], v[252:255], v[244:247], v[112:127]
    s_add_u32 m0, s70, 50176
    s_nop 0
    buffer_load_dwordx4 v129, s[4:7], s66 offen lds
    s_waitcnt lgkmcnt(6)
    v_mfma_f32_32x32x16_bf16 v[64:79], v[152:155], v[144:147], v[64:79]
    ds_read_b128 v[192:195], v19 offset:16384
    ds_read_b64_tr_b16 v[200:201], v132 offset:57344
    v_mfma_f32_32x32x16_bf16 v[80:95], v[152:155], v[148:151], v[80:95]
    ds_read_b64_tr_b16 v[202:203], v133 offset:57344
    ds_read_b128 v[196:199], v19 offset:20480
    v_mfma_f32_32x32x16_bf16 v[96:111], v[156:159], v[144:147], v[96:111]
    ds_read_b64_tr_b16 v[204:205], v134 offset:57344
    ds_read_b64_tr_b16 v[206:207], v135 offset:57344
    s_add_u32 m0, s70, 51200
    s_nop 0
    buffer_load_dwordx4 v130, s[4:7], s66 offen lds
    s_add_u32 s66, s66, s17
    v_mfma_f32_32x32x16_bf16 v[112:127], v[156:159], v[148:151], v[112:127]
    s_add_u32 m0, s70, 52224
    s_nop 0
    buffer_load_dwordx4 v3, s[32:35], s67 offen lds
    s_add_u32 s67, s67, s18
    s_waitcnt lgkmcnt(6)
    v_mfma_f32_32x32x16_bf16 v[64:79], v[184:187], v[176:179], v[64:79]
    s_waitcnt vmcnt(6) lgkmcnt(0)
    s_barrier
    v_mfma_f32_32x32x16_bf16 v[80:95], v[184:187], v[180:183], v[80:95]
    ds_read_b128 v[208:211], v16 offset:32768
    ds_read_b64_tr_b16 v[216:217], v136 offset:0
    v_mfma_f32_32x32x16_bf16 v[96:111], v[188:191], v[176:179], v[96:111]
    ds_read_b64_tr_b16 v[218:219], v137 offset:0
    ds_read_b128 v[212:215], v16 offset:36864
    s_add_u32 s88, s88, 1
    s_cmp_eq_u32 s88, 8
    s_cselect_b32 s3, -6, 1
    s_lshl_b32 s16, s3, 7
    s_mul_i32 s18, s3, 196608
    s_mul_i32 s17, s3, 229376
    s_add_u32 m0, s63, 16384
    s_nop 0
    buffer_load_dwordx4 v2, s[28:31], s64 offen lds
    s_add_u32 s64, s64, s16
    v_mfma_f32_32x32x16_bf16 v[112:127], v[188:191], v[180:183], v[112:127]
    ds_read_b64_tr_b16 v[220:221], v138 offset:0
    ds_read_b64_tr_b16 v[222:223], v139 offset:0
    v_mfma_f32_32x32x16_bf16 v[64:79], v[200:203], v[192:195], v[64:79]
    ds_read_b128 v[224:227], v17 offset:32768
    ds_read_b64_tr_b16 v[232:233], v136 offset:8192
    v_mfma_f32_32x32x16_bf16 v[80:95], v[200:203], v[196:199], v[80:95]
    ds_read_b64_tr_b16 v[234:235], v137 offset:8192
    ds_read_b128 v[228:231], v17 offset:36864
    v_mfma_f32_32x32x16_bf16 v[96:111], v[204:207], v[192:195], v[96:111]
    ds_read_b64_tr_b16 v[236:237], v138 offset:8192
    ds_read_b64_tr_b16 v[238:239], v139 offset:8192
    s_add_u32 m0, s63, 24576
    s_nop 0
    buffer_load_dwordx4 v2, s[28:31], s65 offen lds
    s_add_u32 s65, s65, s16
    v_mfma_f32_32x32x16_bf16 v[112:127], v[204:207], v[196:199], v[112:127]
    s_add_u32 m0, s70, 81920
    s_nop 0
    buffer_load_dwordx4 v128, s[4:7], s66 offen lds
    s_waitcnt lgkmcnt(6)
    v_mfma_f32_32x32x16_bf16 v[64:79], v[216:219], v[208:211], v[64:79]
    ds_read_b128 v[240:243], v18 offset:32768
    ds_read_b64_tr_b16 v[248:249], v136 offset:16384
    v_mfma_f32_32x32x16_bf16 v[80:95], v[216:219], v[212:215], v[80:95]
    ds_read_b64_tr_b16 v[250:251], v137 offset:16384
    ds_read_b128 v[244:247], v18 offset:36864
    v_mfma_f32_32x32x16_bf16 v[96:111], v[220:223], v[208:211], v[96:111]
    ds_read_b64_tr_b16 v[252:253], v138 offset:16384
    ds_read_b64_tr_b16 v[254:255], v139 offset:16384
    s_add_u32 m0, s70, 82944
    s_nop 0
    buffer_load_dwordx4 v129, s[4:7], s66 offen lds
    v_mfma_f32_32x32x16_bf16 v[112:127], v[220:223], v[212:215], v[112:127]
    s_add_u32 m0, s70, 83968
    s_nop 0
    buffer_load_dwordx4 v130, s[4:7], s66 offen lds
    s_add_u32 s66, s66, s17
    s_waitcnt lgkmcnt(6)
    v_mfma_f32_32x32x16_bf16 v[64:79], v[232:235], v[224:227], v[64:79]
    ds_read_b128 v[144:147], v19 offset:32768
    ds_read_b64_tr_b16 v[152:153], v136 offset:24576
    v_mfma_f32_32x32x16_bf16 v[80:95], v[232:235], v[228:231], v[80:95]
    ds_read_b64_tr_b16 v[154:155], v137 offset:24576
    ds_read_b128 v[148:151], v19 offset:36864
    v_mfma_f32_32x32x16_bf16 v[96:111], v[236:239], v[224:227], v[96:111]
    ds_read_b64_tr_b16 v[156:157], v138 offset:24576
    ds_read_b64_tr_b16 v[158:159], v139 offset:24576
    s_add_u32 m0, s70, 84992
    s_nop 0
    buffer_load_dwordx4 v3, s[32:35], s67 offen lds
    s_add_u32 s67, s67, s18
    v_mfma_f32_32x32x16_bf16 v[112:127], v[236:239], v[228:231], v[112:127]
    s_cmp_ge_u32 s60, 2
    s_cbranch_scc1 F_WPHH
    s_lshl_b32 s3, s62, 11
    s_add_u32 s3, s3, s63
    s_add_u32 m0, s63, 155648
    s_nop 0
    buffer_load_dwordx4 v12, s[40:43], s3 offen lds
F_WPHH:
    s_waitcnt lgkmcnt(6)
    v_mfma_f32_32x32x16_bf16 v[64:79], v[248:251], v[240:243], v[64:79]
    s_waitcnt vmcnt(6) lgkmcnt(0)
    s_barrier
    v_mfma_f32_32x32x16_bf16 v[80:95], v[248:251], v[244:247], v[80:95]
    ds_read_b128 v[176:179], v16 offset:0
    ds_read_b64_tr_b16 v[184:185], v132 offset:0
    v_mfma_f32_32x32x16_bf16 v[96:111], v[252:255], v[240:243], v[96:111]
    ds_read_b64_tr_b16 v[186:187], v133 offset:0
    ds_read_b128 v[180:183], v16 offset:4096
    s_add_u32 s88, s88, 1
    s_cmp_eq_u32 s88, 8
    s_cselect_b32 s3, -6, 1
    s_lshl_b32 s16, s3, 7
    s_mul_i32 s18, s3, 196608
    s_mul_i32 s17, s3, 229376
    s_add_u32 m0, s63, 32768
    s_nop 0
    buffer_load_dwordx4 v2, s[28:31], s64 offen lds
    s_add_u32 s64, s64, s16
    v_mfma_f32_32x32x16_bf16 v[112:127], v[252:255], v[244:247], v[112:127]
    ds_read_b64_tr_b16 v[188:189], v134 offset:0
    ds_read_b64_tr_b16 v[190:191], v135 offset:0
    v_mfma_f32_32x32x16_bf16 v[64:79], v[152:155], v[144:147], v[64:79]
    ds_read_b128 v[192:195], v17 offset:0
    ds_read_b64_tr_b16 v[200:201], v132 offset:8192
    v_mfma_f32_32x32x16_bf16 v[80:95], v[152:155], v[148:151], v[80:95]
    ds_read_b64_tr_b16 v[202:203], v133 offset:8192
    ds_read_b128 v[196:199], v17 offset:4096
    v_mfma_f32_32x32x16_bf16 v[96:111], v[156:159], v[144:147], v[96:111]
    ds_read_b64_tr_b16 v[204:205], v134 offset:8192
    ds_read_b64_tr_b16 v[206:207], v135 offset:8192
    s_add_u32 m0, s63, 40960
    s_nop 0
    buffer_load_dwordx4 v2, s[28:31], s65 offen lds
    s_add_u32 s65, s65, s16
    v_mfma_f32_32x32x16_bf16 v[112:127], v[156:159], v[148:151], v[112:127]
    s_add_u32 m0, s70, 114688
    s_nop 0
    buffer_load_dwordx4 v128, s[4:7], s66 offen lds
    s_waitcnt lgkmcnt(6)
    v_mfma_f32_32x32x16_bf16 v[64:79], v[184:187], v[176:179], v[64:79]
    ds_read_b128 v[208:211], v18 offset:0
    ds_read_b64_tr_b16 v[216:217], v132 offset:16384
    v_mfma_f32_32x32x16_bf16 v[80:95], v[184:187], v[180:183], v[80:95]
    ds_read_b64_tr_b16 v[218:219], v133 offset:16384
    ds_read_b128 v[212:215], v18 offset:4096
    v_mfma_f32_32x32x16_bf16 v[96:111], v[188:191], v[176:179], v[96:111]
    ds_read_b64_tr_b16 v[220:221], v134 offset:16384
    ds_read_b64_tr_b16 v[222:223], v135 offset:16384
    s_add_u32 m0, s70, 115712
    s_nop 0
    buffer_load_dwordx4 v129, s[4:7], s66 offen lds
    v_mfma_f32_32x32x16_bf16 v[112:127], v[188:191], v[180:183], v[112:127]
    s_add_u32 m0, s70, 116736
    s_nop 0
    buffer_load_dwordx4 v130, s[4:7], s66 offen lds
    s_add_u32 s66, s66, s17
    s_waitcnt lgkmcnt(6)
    v_mfma_f32_32x32x16_bf16 v[64:79], v[200:203], v[192:195], v[64:79]
    ds_read_b128 v[224:227], v19 offset:0
    ds_read_b64_tr_b16 v[232:233], v132 offset:24576
    v_mfma_f32_32x32x16_bf16 v[80:95], v[200:203], v[196:199], v[80:95]
    ds_read_b64_tr_b16 v[234:235], v133 offset:24576
    ds_read_b128 v[228:231], v19 offset:4096
    v_mfma_f32_32x32x16_bf16 v[96:111], v[204:207], v[192:195], v[96:111]
    ds_read_b64_tr_b16 v[236:237], v134 offset:24576
    ds_read_b64_tr_b16 v[238:239], v135 offset:24576
    s_add_u32 m0, s70, 117760
    s_nop 0
    buffer_load_dwordx4 v3, s[32:35], s67 offen lds
    s_add_u32 s67, s67, s18
    v_mfma_f32_32x32x16_bf16 v[112:127], v[204:207], v[196:199], v[112:127]
    s_waitcnt lgkmcnt(6)
    v_mfma_f32_32x32x16_bf16 v[64:79], v[216:219], v[208:211], v[64:79]
    s_waitcnt vmcnt(6) lgkmcnt(0)
    s_barrier
    v_mfma_f32_32x32x16_bf16 v[80:95], v[216:219], v[212:215], v[80:95]
    ds_read_b128 v[240:243], v16 offset:16384
    ds_read_b64_tr_b16 v[248:249], v132 offset:32768
    v_mfma_f32_32x32x16_bf16 v[96:111], v[220:223], v[208:211], v[96:111]
    ds_read_b64_tr_b16 v[250:251], v133 offset:32768
    ds_read_b128 v[244:247], v16 offset:20480
    s_add_u32 s88, s88, 1
    s_cmp_eq_u32 s88, 8
    s_cselect_b32 s3, -6, 1
    s_lshl_b32 s16, s3, 7
    s_mul_i32 s18, s3, 196608
    s_mul_i32 s17, s3, 229376
    s_add_u32 m0, s63, 0
    s_nop 0
    buffer_load_dwordx4 v2, s[28:31], s64 offen lds
    s_add_u32 s64, s64, s16
    v_mfma_f32_32x32x16_bf16 v[112:127], v[220:223], v[212:215], v[112:127]
    ds_read_b64_tr_b16 v[252:253], v134 offset:32768
    ds_read_b64_tr_b16 v[254:255], v135 offset:32768
    v_mfma_f32_32x32x16_bf16 v[64:79], v[232:235], v[224:227], v[64:79]
    ds_read_b128 v[144:147], v17 offset:16384
    ds_read_b64_tr_b16 v[152:153], v132 offset:40960
    v_mfma_f32_32x32x16_bf16 v[80:95], v[232:235], v[228:231], v[80:95]
    ds_read_b64_tr_b16 v[154:155], v133 offset:40960
    ds_read_b128 v[148:151], v17 offset:20480
    v_mfma_f32_32x32x16_bf16 v[96:111], v[236:239], v[224:227], v[96:111]
    ds_read_b64_tr_b16 v[156:157], v134 offset:40960
    ds_read_b64_tr_b16 v[158:159], v135 offset:40960
    s_add_u32 m0, s63, 8192
    s_nop 0
    buffer_load_dwordx4 v2, s[28:31], s65 offen lds
    s_add_u32 s65, s65, s16
    v_mfma_f32_32x32x16_bf16 v[112:127], v[236:239], v[228:231], v[112:127]
    s_add_u32 m0, s70, 49152
    s_nop 0
    buffer_load_dwordx4 v128, s[4:7], s66 offen lds
    s_waitcnt lgkmcnt(6)
    v_mfma_f32_32x32x16_bf16 v[64:79], v[248:251], v[240:243], v[64:79]
    ds_read_b128 v[176:179], v18 offset:16384
    ds_read_b64_tr_b16 v[184:185], v132 offset:49152
    v_mfma_f32_32x32x16_bf16 v[80:95], v[248:251], v[244:247], v[80:95]
    ds_read_b64_tr_b16 v[186:187], v133 offset:49152
    ds_read_b128 v[180:183], v18 offset:20480
    v_mfma_f32_32x32x16_bf16 v[96:111], v[252:255], v[240:243], v[96:111]
    ds_read_b64_tr_b16 v[188:189], v134 offset:49152
    ds_read_b64_tr_b16 v[190:191], v135 offset:49152
    s_add_u32 m0, s70, 50176
    s_nop 0
    buffer_load_dwordx4 v129, s[4:7], s66 offen lds
    v_mfma_f32_32x32x16_bf16 v[112:127], v[252:255], v[244:247], v[112:127]
    s_add_u32 m0, s70, 51200
    s_nop 0
    buffer_load_dwordx4 v130, s[4:7], s66 offen lds
    s_add_u32 s66, s66, s17
    s_waitcnt lgkmcnt(6)
    v_mfma_f32_32x32x16_bf16 v[64:79], v[152:155], v[144:147], v[64:79]
    ds_read_b128 v[192:195], v19 offset:16384
    ds_read_b64_tr_b16 v[200:201], v132 offset:57344
    v_mfma_f32_32x32x16_bf16 v[80:95], v[152:155], v[148:151], v[80:95]
    ds_read_b64_tr_b16 v[202:203], v133 offset:57344
    ds_read_b128 v[196:199], v19 offset:20480
    v_mfma_f32_32x32x16_bf16 v[96:111], v[156:159], v[144:147], v[96:111]
    ds_read_b64_tr_b16 v[204:205], v134 offset:57344
    ds_read_b64_tr_b16 v[206:207], v135 offset:57344
    s_add_u32 m0, s70, 52224
    s_nop 0
    buffer_load_dwordx4 v3, s[32:35], s67 offen lds
    s_add_u32 s67, s67, s18
    v_mfma_f32_32x32x16_bf16 v[112:127], v[156:159], v[148:151], v[112:127]
    s_waitcnt lgkmcnt(6)
    v_mfma_f32_32x32x16_bf16 v[64:79], v[184:187], v[176:179], v[64:79]
    s_waitcnt vmcnt(6) lgkmcnt(0)
    s_barrier
    v_mfma_f32_32x32x16_bf16 v[80:95], v[184:187], v[180:183], v[80:95]
    ds_read_b128 v[208:211], v16 offset:32768
    ds_read_b64_tr_b16 v[216:217], v136 offset:0
    v_mfma_f32_32x32x16_bf16 v[96:111], v[188:191], v[176:179], v[96:111]
    ds_read_b64_tr_b16 v[218:219], v137 offset:0
    ds_read_b128 v[212:215], v16 offset:36864
    s_add_u32 m0, s63, 16384
    s_nop 0
    buffer_load_dwordx4 v2, s[28:31], s64 offen lds
    v_mfma_f32_32x32x16_bf16 v[112:127], v[188:191], v[180:183], v[112:127]
    ds_read_b64_tr_b16 v[220:221], v138 offset:0
    ds_read_b64_tr_b16 v[222:223], v139 offset:0
    v_mfma_f32_32x32x16_bf16 v[64:79], v[200:203], v[192:195], v[64:79]
    ds_read_b128 v[224:227], v17 offset:32768
    ds_read_b64_tr_b16 v[232:233], v136 offset:8192
    v_mfma_f32_32x32x16_bf16 v[80:95], v[200:203], v[196:199], v[80:95]
    ds_read_b64_tr_b16 v[234:235], v137 offset:8192
    ds_read_b128 v[228:231], v17 offset:36864
    v_mfma_f32_32x32x16_bf16 v[96:111], v[204:207], v[192:195], v[96:111]
    ds_read_b64_tr_b16 v[236:237], v138 offset:8192
    ds_read_b64_tr_b16 v[238:239], v139 offset:8192
    s_add_u32 m0, s63, 24576
    s_nop 0
    buffer_load_dwordx4 v2, s[28:31], s65 offen lds
    v_mfma_f32_32x32x16_bf16 v[112:127], v[204:207], v[196:199], v[112:127]
    s_add_u32 m0, s70, 81920
    s_nop 0
    buffer_load_dwordx4 v128, s[4:7], s66 offen lds
    s_waitcnt lgkmcnt(6)
    v_mfma_f32_32x32x16_bf16 v[64:79], v[216:219], v[208:211], v[64:79]
    ds_read_b128 v[240:243], v18 offset:32768
    ds_read_b64_tr_b16 v[248:249], v136 offset:16384
    v_mfma_f32_32x32x16_bf16 v[80:95], v[216:219], v[212:215], v[80:95]
    ds_read_b64_tr_b16 v[250:251], v137 offset:16384
    ds_read_b128 v[244:247], v18 offset:36864
    v_mfma_f32_32x32x16_bf16 v[96:111], v[220:223], v[208:211], v[96:111]
    ds_read_b64_tr_b16 v[252:253], v138 offset:16384
    ds_read_b64_tr_b16 v[254:255], v139 offset:16384
    s_add_u32 m0, s70, 82944
    s_nop 0
    buffer_load_dwordx4 v129, s[4:7], s66 offen lds
    v_mfma_f32_32x32x16_bf16 v[112:127], v[220:223], v[212:215], v[112:127]
    s_add_u32 m0, s70, 83968
    s_nop 0
    buffer_load_dwordx4 v130, s[4:7], s66 offen lds
    s_waitcnt lgkmcnt(6)
    v_mfma_f32_32x32x16_bf16 v[64:79], v[232:235], v[224:227], v[64:79]
    ds_read_b128 v[144:147], v19 offset:32768
    ds_read_b64_tr_b16 v[152:153], v136 offset:24576
    v_mfma_f32_32x32x16_bf16 v[80:95], v[232:235], v[228:231], v[80:95]
    ds_read_b64_tr_b16 v[154:155], v137 offset:24576
    ds_read_b128 v[148:151], v19 offset:36864
    v_mfma_f32_32x32x16_bf16 v[96:111], v[236:239], v[224:227], v[96:111]
    ds_read_b64_tr_b16 v[156:157], v138 offset:24576
    ds_read_b64_tr_b16 v[158:159], v139 offset:24576
    s_add_u32 m0, s70, 84992
    s_nop 0
    buffer_load_dwordx4 v3, s[32:35], s67 offen lds
    v_mfma_f32_32x32x16_bf16 v[112:127], v[236:239], v[228:231], v[112:127]
    buffer_load_dwordx2 v[22:23], v7, s[56:59], 0 offen sc1
    s_waitcnt lgkmcnt(6)
    v_mfma_f32_32x32x16_bf16 v[64:79], v[248:251], v[240:243], v[64:79]
    s_waitcnt vmcnt(7) lgkmcnt(0)
    s_barrier
    v_mfma_f32_32x32x16_bf16 v[80:95], v[248:251], v[244:247], v[80:95]
    ds_read_b128 v[176:179], v16 offset:0
    ds_read_b64_tr_b16 v[184:185], v132 offset:0
    v_mfma_f32_32x32x16_bf16 v[96:111], v[252:255], v[240:243], v[96:111]
    ds_read_b64_tr_b16 v[186:187], v133 offset:0
    ds_read_b128 v[180:183], v16 offset:4096
    v_mfma_f32_32x32x16_bf16 v[112:127], v[252:255], v[244:247], v[112:127]
    ds_read_b64_tr_b16 v[188:189], v134 offset:0
    ds_read_b64_tr_b16 v[190:191], v135 offset:0
    v_mfma_f32_32x32x16_bf16 v[64:79], v[152:155], v[144:147], v[64:79]
    ds_read_b128 v[192:195], v17 offset:0
    ds_read_b64_tr_b16 v[200:201], v132 offset:8192
    v_mfma_f32_32x32x16_bf16 v[80:95], v[152:155], v[148:151], v[80:95]
    ds_read_b64_tr_b16 v[202:203], v133 offset:8192
    ds_read_b128 v[196:199], v17 offset:4096
    v_mfma_f32_32x32x16_bf16 v[96:111], v[156:159], v[144:147], v[96:111]
    ds_read_b64_tr_b16 v[204:205], v134 offset:8192
    ds_read_b64_tr_b16 v[206:207], v135 offset:8192
    s_add_u32 m0, s24, 147456
    s_add_u32 s20, s23, 0
    buffer_load_dwordx4 v15, s[44:47], s20 offen lds
    v_mfma_f32_32x32x16_bf16 v[112:127], v[156:159], v[148:151], v[112:127]
    s_add_u32 m0, s24, 32768
    s_add_u32 s20, s23, 16384
    buffer_load_dwordx4 v15, s[44:47], s20 offen lds
    s_waitcnt lgkmcnt(6)
    v_mfma_f32_32x32x16_bf16 v[64:79], v[184:187], v[176:179], v[64:79]
    ds_read_b128 v[208:211], v18 offset:0
    ds_read_b64_tr_b16 v[216:217], v132 offset:16384
    v_mfma_f32_32x32x16_bf16 v[80:95], v[184:187], v[180:183], v[80:95]
    ds_read_b64_tr_b16 v[218:219], v133 offset:16384
    ds_read_b128 v[212:215], v18 offset:4096
    v_mfma_f32_32x32x16_bf16 v[96:111], v[188:191], v[176:179], v[96:111]
    ds_read_b64_tr_b16 v[220:221], v134 offset:16384
    ds_read_b64_tr_b16 v[222:223], v135 offset:16384
    s_add_u32 m0, s24, 40960
    s_add_u32 s20, s23, 32768
    buffer_load_dwordx4 v15, s[44:47], s20 offen lds
    v_mfma_f32_32x32x16_bf16 v[112:127], v[188:191], v[180:183], v[112:127]
    s_add_u32 m0, s24, 114688
    s_add_u32 s20, s23, 49152
    buffer_load_dwordx4 v15, s[44:47], s20 offen lds
    s_waitcnt lgkmcnt(6)
    v_mfma_f32_32x32x16_bf16 v[64:79], v[200:203], v[192:195], v[64:79]
    ds_read_b128 v[224:227], v19 offset:0
    ds_read_b64_tr_b16 v[232:233], v132 offset:24576
    v_mfma_f32_32x32x16_bf16 v[80:95], v[200:203], v[196:199], v[80:95]
    ds_read_b64_tr_b16 v[234:235], v133 offset:24576
    ds_read_b128 v[228:231], v19 offset:4096
    v_mfma_f32_32x32x16_bf16 v[96:111], v[204:207], v[192:195], v[96:111]
    ds_read_b64_tr_b16 v[236:237], v134 offset:24576
    ds_read_b64_tr_b16 v[238:239], v135 offset:24576
    s_add_u32 m0, s24, 122880
    s_add_u32 s20, s23, 65536
    buffer_load_dwordx4 v15, s[44:47], s20 offen lds
    v_mfma_f32_32x32x16_bf16 v[112:127], v[204:207], v[196:199], v[112:127]
    s_add_u32 m0, s24, 131072
    s_add_u32 s20, s23, 81920
    buffer_load_dwordx4 v15, s[44:47], s20 offen lds
    v_lshl_add_u32 v4, v9, 2, v10
    v_lshlrev_b32 v4, 5, v4
    v_bfe_u32 v5, v0, 4, 1
    v_lshl_add_u32 v4, v5, 4, v4
    v_bfe_u32 v5, v0, 1, 1
    v_lshl_add_u32 v6, v5, 3, v4
    s_lshl_b32 s3, s83, 9
    s_add_u32 s3, s3, 155648
    v_add_u32 v6, s3, v6
    ds_read_b64_tr_b16 v[24:25], v6 offset:0
    ds_read_b64_tr_b16 v[26:27], v6 offset:256
    v_bfe_u32 v140, v0, 2, 1
    v_mul_u32_u24 v140, 0x8000, v140
    v_lshl_or_b32 v140, v140, 16, v140
    s_waitcnt lgkmcnt(6)
    v_mfma_f32_32x32x16_bf16 v[64:79], v[216:219], v[208:211], v[64:79]
    s_waitcnt vmcnt(7) lgkmcnt(0)
    s_barrier
    v_mfma_f32_32x32x16_bf16 v[80:95], v[216:219], v[212:215], v[80:95]
    ds_read_b128 v[240:243], v16 offset:16384
    ds_read_b64_tr_b16 v[248:249], v132 offset:32768
    v_mfma_f32_32x32x16_bf16 v[96:111], v[220:223], v[208:211], v[96:111]
    ds_read_b64_tr_b16 v[250:251], v133 offset:32768
    ds_read_b128 v[244:247], v16 offset:20480
    s_add_u32 m0, s24, 139264
    s_add_u32 s20, s23, 98304
    buffer_load_dwordx4 v15, s[44:47], s20 offen lds
    v_mfma_f32_32x32x16_bf16 v[112:127], v[220:223], v[212:215], v[112:127]
    ds_read_b64_tr_b16 v[252:253], v134 offset:32768
    ds_read_b64_tr_b16 v[254:255], v135 offset:32768
    s_add_u32 m0, s24, 0
    s_add_u32 s20, s23, 114688
    buffer_load_dwordx4 v15, s[44:47], s20 offen lds
    v_mfma_f32_32x32x16_bf16 v[64:79], v[232:235], v[224:227], v[64:79]
    ds_read_b128 v[144:147], v17 offset:16384
    ds_read_b64_tr_b16 v[152:153], v132 offset:40960
    v_mfma_f32_32x32x16_bf16 v[80:95], v[232:235], v[228:231], v[80:95]
    ds_read_b64_tr_b16 v[154:155], v133 offset:40960
    ds_read_b128 v[148:151], v17 offset:20480
    v_mfma_f32_32x32x16_bf16 v[96:111], v[236:239], v[224:227], v[96:111]
    ds_read_b64_tr_b16 v[156:157], v134 offset:40960
    ds_read_b64_tr_b16 v[158:159], v135 offset:40960
    s_add_u32 m0, s24, 8192
    s_add_u32 s20, s23, 131072
    buffer_load_dwordx4 v15, s[44:47], s20 offen lds
    v_mfma_f32_32x32x16_bf16 v[112:127], v[236:239], v[228:231], v[112:127]
    s_add_u32 m0, s24, 49152
    s_add_u32 s20, s23, 147456
    buffer_load_dwordx4 v15, s[44:47], s20 offen lds
    s_waitcnt lgkmcnt(6)
    v_mfma_f32_32x32x16_bf16 v[64:79], v[248:251], v[240:243], v[64:79]
    ds_read_b128 v[176:179], v18 offset:16384
    ds_read_b64_tr_b16 v[184:185], v132 offset:49152
    v_mfma_f32_32x32x16_bf16 v[80:95], v[248:251], v[244:247], v[80:95]
    ds_read_b64_tr_b16 v[186:187], v133 offset:49152
    ds_read_b128 v[180:183], v18 offset:20480
    v_mfma_f32_32x32x16_bf16 v[96:111], v[252:255], v[240:243], v[96:111]
    ds_read_b64_tr_b16 v[188:189], v134 offset:49152
    ds_read_b64_tr_b16 v[190:191], v135 offset:49152
    s_add_u32 m0, s24, 57344
    s_add_u32 s20, s23, 163840
    buffer_load_dwordx4 v15, s[44:47], s20 offen lds
    v_mfma_f32_32x32x16_bf16 v[112:127], v[252:255], v[244:247], v[112:127]
    s_waitcnt lgkmcnt(6)
    v_mfma_f32_32x32x16_bf16 v[64:79], v[152:155], v[144:147], v[64:79]
    ds_read_b128 v[192:195], v19 offset:16384
    ds_read_b64_tr_b16 v[200:201], v132 offset:57344
    v_mfma_f32_32x32x16_bf16 v[80:95], v[152:155], v[148:151], v[80:95]
    ds_read_b64_tr_b16 v[202:203], v133 offset:57344
    ds_read_b128 v[196:199], v19 offset:20480
    v_mfma_f32_32x32x16_bf16 v[96:111], v[156:159], v[144:147], v[96:111]
    ds_read_b64_tr_b16 v[204:205], v134 offset:57344
    ds_read_b64_tr_b16 v[206:207], v135 offset:57344
    s_waitcnt lgkmcnt(0)
    v_xor_b32 v24, v24, v140
    v_xor_b32 v25, v25, v140
    v_xor_b32 v26, v26, v140
    v_xor_b32 v27, v27, v140
    v_mfma_f32_32x32x16_bf16 v[112:127], v[156:159], v[148:151], v[112:127]
    v_and_b32 v5, 15, v0
    v_lshlrev_b32 v5, 2, v5
    v_lshl_add_u32 v5, v9, 6, v5
    v_lshlrev_b32 v6, 2, v9
    v_add_u32 v6, 2048, v6
    v_bfe_u32 v4, v0, 4, 1
    v_cmp_eq_u32 vcc, 1, v4
    s_nop 1
    v_cndmask_b32 v14, v5, v6, vcc
    v_mov_b32 v6, 128
    v_cndmask_b32 v2, v6, 8, vcc
    s_lshl_b32 s26, s62, 2
    s_add_u32 s26, s26, s83
    s_mul_i32 s68, s26, 2304
    s_add_u32 s68, s68, 10485760
    s_lshl_b32 s26, s26, 11
    s_mul_i32 s3, s61, 590080
    s_add_u32 s3, s3, s26
    s_add_u32 s69, s3, 229376
    s_waitcnt lgkmcnt(6)
    v_mfma_f32_32x32x16_bf16 v[64:79], v[184:187], v[176:179], v[64:79]
    v_mfma_f32_32x32x16_bf16 v[80:95], v[184:187], v[180:183], v[80:95]
    v_mfma_f32_32x32x16_bf16 v[96:111], v[188:191], v[176:179], v[96:111]
    v_mfma_f32_32x32x16_bf16 v[112:127], v[188:191], v[180:183], v[112:127]
    s_waitcnt lgkmcnt(0)
    v_mfma_f32_32x32x16_bf16 v[64:79], v[200:203], v[192:195], v[64:79]
    v_mfma_f32_32x32x16_bf16 v[80:95], v[200:203], v[196:199], v[80:95]
    v_mfma_f32_32x32x16_bf16 v[96:111], v[204:207], v[192:195], v[96:111]
    v_mfma_f32_32x32x16_bf16 v[112:127], v[204:207], v[196:199], v[112:127]
    s_cmp_eq_u32 s71, 3
    s_cbranch_scc1 F_HQQ
    s_nop 6
    v_cvt_pk_bf16_f32 v32, v64, v65
    v_cvt_pk_bf16_f32 v33, v66, v67
    v_cvt_pk_bf16_f32 v34, v68, v69
    v_cvt_pk_bf16_f32 v35, v70, v71
    v_cvt_pk_bf16_f32 v36, v72, v73
    v_cvt_pk_bf16_f32 v37, v74, v75
    v_cvt_pk_bf16_f32 v38, v76, v77
    v_cvt_pk_bf16_f32 v39, v78, v79
    v_pk_max_i16 v32, v32, 0
    v_pk_max_i16 v33, v33, 0
    v_pk_max_i16 v34, v34, 0
    v_pk_max_i16 v35, v35, 0
    v_pk_max_i16 v36, v36, 0
    v_pk_max_i16 v37, v37, 0
    v_pk_max_i16 v38, v38, 0
    v_pk_max_i16 v39, v39, 0
    buffer_store_dwordx4 v[32:35], v12, s[36:39], s72 offen offset:0 sc1
    buffer_store_dwordx4 v[36:39], v12, s[36:39], s72 offen offset:2048 sc1
    v_cvt_pk_bf16_f32 v40, v80, v81
    v_cvt_pk_bf16_f32 v41, v82, v83
    v_cvt_pk_bf16_f32 v42, v84, v85
    v_cvt_pk_bf16_f32 v43, v86, v87
    v_cvt_pk_bf16_f32 v44, v88, v89
    v_cvt_pk_bf16_f32 v45, v90, v91
    v_cvt_pk_bf16_f32 v46, v92, v93
    v_cvt_pk_bf16_f32 v47, v94, v95
    v_pk_max_i16 v40, v40, 0
    v_pk_max_i16 v41, v41, 0
    v_pk_max_i16 v42, v42, 0
    v_pk_max_i16 v43, v43, 0
    v_pk_max_i16 v44, v44, 0
    v_pk_max_i16 v45, v45, 0
    v_pk_max_i16 v46, v46, 0
    v_pk_max_i16 v47, v47, 0
    buffer_store_dwordx4 v[40:43], v12, s[36:39], s72 offen offset:1024 sc1
    buffer_store_dwordx4 v[44:47], v12, s[36:39], s72 offen offset:3072 sc1
    v_cvt_pk_bf16_f32 v48, v96, v97
    v_cvt_pk_bf16_f32 v49, v98, v99
    v_cvt_pk_bf16_f32 v50, v100, v101
    v_cvt_pk_bf16_f32 v51, v102, v103
    v_cvt_pk_bf16_f32 v52, v104, v105
    v_cvt_pk_bf16_f32 v53, v106, v107
    v_cvt_pk_bf16_f32 v54, v108, v109
    v_cvt_pk_bf16_f32 v55, v110, v111
    v_pk_max_i16 v48, v48, 0
    v_pk_max_i16 v49, v49, 0
    v_pk_max_i16 v50, v50, 0
    v_pk_max_i16 v51, v51, 0
    v_pk_max_i16 v52, v52, 0
    v_pk_max_i16 v53, v53, 0
    v_pk_max_i16 v54, v54, 0
    v_pk_max_i16 v55, v55, 0
    buffer_store_dwordx4 v[48:51], v12, s[36:39], s73 offen offset:0 sc1
    buffer_store_dwordx4 v[52:55], v12, s[36:39], s73 offen offset:2048 sc1
    v_cvt_pk_bf16_f32 v56, v112, v113
    v_cvt_pk_bf16_f32 v57, v114, v115
    v_cvt_pk_bf16_f32 v58, v116, v117
    v_cvt_pk_bf16_f32 v59, v118, v119
    v_cvt_pk_bf16_f32 v60, v120, v121
    v_cvt_pk_bf16_f32 v61, v122, v123
    v_cvt_pk_bf16_f32 v62, v124, v125
    v_cvt_pk_bf16_f32 v63, v126, v127
    v_pk_max_i16 v56, v56, 0
    v_pk_max_i16 v57, v57, 0
    v_pk_max_i16 v58, v58, 0
    v_pk_max_i16 v59, v59, 0
    v_pk_max_i16 v60, v60, 0
    v_pk_max_i16 v61, v61, 0
    v_pk_max_i16 v62, v62, 0
    v_pk_max_i16 v63, v63, 0
    buffer_store_dwordx4 v[56:59], v12, s[36:39], s73 offen offset:1024 sc1
    buffer_store_dwordx4 v[60:63], v12, s[36:39], s73 offen offset:3072 sc1
    v_lshl_add_u32 v4, v9, 2, v10
    v_lshlrev_b32 v4, 7, v4
    s_and_b32 s3, s83, 1
    s_lshl_b32 s3, s3, 5
    v_xor_b32 v5, s3, v11
    v_add_u32 v4, v4, v5
    s_lshl_b32 s3, s83, 11
    v_add_u32 v4, s3, v4
    s_lshr_b32 s3, s83, 1
    v_lshrrev_b32 v5, 1, v10
    v_xor_b32 v5, s3, v5
    v_lshl_add_u32 v16, v5, 6, v4
    v_xor_b32 v17, 64, v16
    v_add_u32 v18, 65536, v16
    v_add_u32 v20, 131072, v16
    v_add_u32 v19, 65536, v17
    v_add_u32 v21, 131072, v17
    v_and_b32 v3, 15, v0
    v_lshlrev_b32 v3, 7, v3
    s_cmp_lg_u32 s100, 0
    s_cselect_b32 s3, 2, 0
    v_and_b32 v4, s3, v0
    v_lshlrev_b32 v4, 9, v4
    v_and_b32 v5, 1, v0
    v_lshlrev_b32 v5, 7, v5
    s_lshl_b32 s3, s83, 8
    v_add_u32 v10, s3, v5
    v_add_u32 v11, v4, v10
    v_lshlrev_b32 v1, 2, v8
    s_lshr_b32 s27, s79, 1
    s_lshl_b32 s70, s27, 11
    s_add_u32 s70, s70, 14761984
    s_lshl_b32 s27, s27, 10
    s_lshl_b32 s3, s83, 8
    s_add_u32 s27, s27, s3
    s_add_u32 s19, s27, 14794752
    s_add_u32 s3, s70, 1024
    s_sub_u32 s26, s19, s3
    s_mov_b32 s19, s3
    v_lshlrev_b32 v4, 7, v0
    v_add_u32 v4, s26, v4
    v_cmp_gt_u32 vcc, 2, v0
    s_nop 1
    v_cndmask_b32 v13, v7, v4, vcc
    v_lshrrev_b32 v4, 1, v0
    v_cmp_eq_u32 vcc, 1, v4
    s_nop 1
    v_cndmask_b32 v13, v13, v10, vcc
    s_mul_i32 s85, s79, 295040
    s_lshl_b32 s3, s84, 10
    s_add_u32 s85, s85, s3
    s_lshl_b32 s3, s83, 14
    s_add_u32 s86, s85, s3
    s_add_u32 s86, s86, 229376
    s_mul_i32 s3, s83, 57344
    s_add_u32 s85, s85, s3
    s_mul_i32 s3, s100, 14336
    s_add_u32 s85, s85, s3
    s_lshl_b32 s3, s79, 8
    s_lshl_b32 s26, s84, 7
    s_add_u32 s3, s3, s26
    s_add_u32 s21, s3, 14680064
    s_waitcnt vmcnt(8)
    s_branch F_HQ1
F_HQQ:
    s_nop 7
    s_nop 3
    s_lshl_b32 s3, s87, 13
    s_add_u32 s3, s3, 65536
    v_add_u32 v141, s3, v12
    v_cvt_pk_bf16_f32 v32, v64, v65
    v_cvt_pk_bf16_f32 v33, v66, v67
    v_cvt_pk_bf16_f32 v34, v68, v69
    v_cvt_pk_bf16_f32 v35, v70, v71
    v_cvt_pk_bf16_f32 v36, v72, v73
    v_cvt_pk_bf16_f32 v37, v74, v75
    v_cvt_pk_bf16_f32 v38, v76, v77
    v_cvt_pk_bf16_f32 v39, v78, v79
    ds_write_b128 v141, v[32:35] offset:0
    ds_write_b128 v141, v[36:39] offset:1024
    v_cvt_pk_bf16_f32 v40, v80, v81
    v_cvt_pk_bf16_f32 v41, v82, v83
    v_cvt_pk_bf16_f32 v42, v84, v85
    v_cvt_pk_bf16_f32 v43, v86, v87
    v_cvt_pk_bf16_f32 v44, v88, v89
    v_cvt_pk_bf16_f32 v45, v90, v91
    v_cvt_pk_bf16_f32 v46, v92, v93
    v_cvt_pk_bf16_f32 v47, v94, v95
    ds_write_b128 v141, v[40:43] offset:4096
    ds_write_b128 v141, v[44:47] offset:5120
    v_cvt_pk_bf16_f32 v48, v96, v97
    v_cvt_pk_bf16_f32 v49, v98, v99
    v_cvt_pk_bf16_f32 v50, v100, v101
    v_cvt_pk_bf16_f32 v51, v102, v103
    v_cvt_pk_bf16_f32 v52, v104, v105
    v_cvt_pk_bf16_f32 v53, v106, v107
    v_cvt_pk_bf16_f32 v54, v108, v109
    v_cvt_pk_bf16_f32 v55, v110, v111
    ds_write_b128 v141, v[48:51] offset:2048
    ds_write_b128 v141, v[52:55] offset:3072
    v_cvt_pk_bf16_f32 v56, v112, v113
    v_cvt_pk_bf16_f32 v57, v114, v115
    v_cvt_pk_bf16_f32 v58, v116, v117
    v_cvt_pk_bf16_f32 v59, v118, v119
    v_cvt_pk_bf16_f32 v60, v120, v121
    v_cvt_pk_bf16_f32 v61, v122, v123
    v_cvt_pk_bf16_f32 v62, v124, v125
    v_cvt_pk_bf16_f32 v63, v126, v127
    ds_write_b128 v141, v[56:59] offset:6144
    ds_write_b128 v141, v[60:63] offset:7168
    v_lshl_add_u32 v4, v9, 2, v10
    v_lshlrev_b32 v4, 7, v4
    s_and_b32 s3, s83, 1
    s_lshl_b32 s3, s3, 5
    v_xor_b32 v5, s3, v11
    v_add_u32 v4, v4, v5
    s_lshl_b32 s3, s83, 11
    v_add_u32 v4, s3, v4
    s_lshr_b32 s3, s83, 1
    v_lshrrev_b32 v5, 1, v10
    v_xor_b32 v5, s3, v5
    v_lshl_add_u32 v16, v5, 6, v4
    v_xor_b32 v17, 64, v16
    v_add_u32 v18, 65536, v16
    v_add_u32 v20, 131072, v16
    v_add_u32 v19, 65536, v17
    v_add_u32 v21, 131072, v17
    v_and_b32 v3, 15, v0
    v_lshlrev_b32 v3, 7, v3
    s_cmp_lg_u32 s100, 0
    s_cselect_b32 s3, 2, 0
    v_and_b32 v4, s3, v0
    v_lshlrev_b32 v4, 9, v4
    v_and_b32 v5, 1, v0
    v_lshlrev_b32 v5, 7, v5
    s_lshl_b32 s3, s83, 8
    v_add_u32 v10, s3, v5
    v_add_u32 v11, v4, v10
    v_lshlrev_b32 v1, 2, v8
    s_lshr_b32 s27, s79, 1
    s_lshl_b32 s70, s27, 11
    s_add_u32 s70, s70, 14761984
    s_lshl_b32 s27, s27, 10
    s_lshl_b32 s3, s83, 8
    s_add_u32 s27, s27, s3
    s_add_u32 s19, s27, 14794752
    s_add_u32 s3, s70, 1024
    s_sub_u32 s26, s19, s3
    s_mov_b32 s19, s3
    v_lshlrev_b32 v4, 7, v0
    v_add_u32 v4, s26, v4
    v_cmp_gt_u32 vcc, 2, v0
    s_nop 1
    v_cndmask_b32 v13, v7, v4, vcc
    v_lshrrev_b32 v4, 1, v0
    v_cmp_eq_u32 vcc, 1, v4
    s_nop 1
    v_cndmask_b32 v13, v13, v10, vcc
    s_mul_i32 s85, s79, 295040
    s_lshl_b32 s3, s84, 10
    s_add_u32 s85, s85, s3
    s_lshl_b32 s3, s83, 14
    s_add_u32 s86, s85, s3
    s_add_u32 s86, s86, 229376
    s_mul_i32 s3, s83, 57344
    s_add_u32 s85, s85, s3
    s_mul_i32 s3, s100, 14336
    s_add_u32 s85, s85, s3
    s_lshl_b32 s3, s79, 8
    s_lshl_b32 s26, s84, 7
    s_add_u32 s3, s3, s26
    s_add_u32 s21, s3, 14680064
    s_waitcnt vmcnt(0) lgkmcnt(0)
F_HQ1:
    s_barrier
    s_mov_b32 s87, 0
F_EH_S:
    v_cmp_eq_u32 vcc, 0, v22
    s_cbranch_vccz F_EH_G
    s_add_u32 s87, s87, 1
    s_cmp_ge_u32 s87, 0x20000
    s_cbranch_scc1 F_EH_G
    buffer_load_dwordx2 v[22:23], v7, s[56:59], 0 offen sc1
    s_waitcnt vmcnt(0)
    s_sleep 2
    s_branch F_EH_S
F_EH_G:
    s_cmp_ge_u32 s60, 4
    s_cbranch_scc1 F_HL
    s_lshl_b32 s3, s83, 10
    s_add_u32 s3, s3, 65536
    v_add_u32 v4, s3, v12
    ds_read_b128 v[40:43], v4 offset:0
    ds_read_b128 v[44:47], v4 offset:4096
    ds_read_b128 v[48:51], v4 offset:8192
    ds_read_b128 v[52:55], v4 offset:12288
    s_waitcnt lgkmcnt(2)
    v_mfma_f32_32x32x16_bf16 v[80:95], v[24:27], v[40:43], 0
    v_mfma_f32_32x32x16_bf16 v[96:111], v[24:27], v[44:47], 0
    ds_read_b64_tr_b16 v[112:113], v20 offset:16384
    ds_read_b64_tr_b16 v[114:115], v20 offset:17408
    ds_read_b64_tr_b16 v[116:117], v21 offset:16384
    ds_read_b64_tr_b16 v[118:119], v21 offset:17408
    ds_read_b64_tr_b16 v[120:121], v16 offset:32768
    ds_read_b64_tr_b16 v[122:123], v16 offset:33792
    ds_read_b64_tr_b16 v[124:125], v17 offset:32768
    ds_read_b64_tr_b16 v[126:127], v17 offset:33792
    ds_read_b64_tr_b16 v[128:129], v16 offset:40960
    ds_read_b64_tr_b16 v[130:131], v16 offset:41984
    ds_read_b64_tr_b16 v[132:133], v17 offset:40960
    ds_read_b64_tr_b16 v[134:135], v17 offset:41984
    ds_read_b64_tr_b16 v[136:137], v18 offset:49152
    ds_read_b64_tr_b16 v[138:139], v18 offset:50176
    ds_read_b64_tr_b16 v[140:141], v19 offset:49152
    ds_read_b64_tr_b16 v[142:143], v19 offset:50176
    ds_read_b64_tr_b16 v[144:145], v18 offset:57344
    ds_read_b64_tr_b16 v[146:147], v18 offset:58368
    ds_read_b64_tr_b16 v[148:149], v19 offset:57344
    ds_read_b64_tr_b16 v[150:151], v19 offset:58368
    ds_read_b64_tr_b16 v[152:153], v20 offset:0
    ds_read_b64_tr_b16 v[154:155], v20 offset:1024
    ds_read_b64_tr_b16 v[156:157], v21 offset:0
    ds_read_b64_tr_b16 v[158:159], v21 offset:1024
    ds_read_b64_tr_b16 v[160:161], v20 offset:8192
    ds_read_b64_tr_b16 v[162:163], v20 offset:9216
    ds_read_b64_tr_b16 v[164:165], v21 offset:8192
    ds_read_b64_tr_b16 v[166:167], v21 offset:9216
    ds_read_b64_tr_b16 v[168:169], v16 offset:0
    ds_read_b64_tr_b16 v[170:171], v16 offset:1024
    ds_read_b64_tr_b16 v[172:173], v17 offset:0
    ds_read_b64_tr_b16 v[174:175], v17 offset:1024
    ds_read_b64_tr_b16 v[176:177], v16 offset:8192
    ds_read_b64_tr_b16 v[178:179], v16 offset:9216
    ds_read_b64_tr_b16 v[180:181], v17 offset:8192
    ds_read_b64_tr_b16 v[182:183], v17 offset:9216
    ds_read_b64_tr_b16 v[184:185], v16 offset:49152
    ds_read_b64_tr_b16 v[186:187], v16 offset:50176
    ds_read_b64_tr_b16 v[188:189], v17 offset:49152
    ds_read_b64_tr_b16 v[190:191], v17 offset:50176
    ds_read_b64_tr_b16 v[192:193], v16 offset:57344
    ds_read_b64_tr_b16 v[194:195], v16 offset:58368
    ds_read_b64_tr_b16 v[196:197], v17 offset:57344
    ds_read_b64_tr_b16 v[198:199], v17 offset:58368
    s_waitcnt lgkmcnt(0)
    s_barrier
    s_setprio 1
    v_max3_f32 v4, v80, v81, v82
    v_max3_f32 v36, v96, v97, v98
    v_max3_f32 v5, v83, v84, v85
    v_max3_f32 v37, v99, v100, v101
    v_max3_f32 v4, v4, v86, v87
    v_max3_f32 v36, v36, v102, v103
    v_max3_f32 v5, v5, v88, v89
    v_max3_f32 v37, v37, v104, v105
    v_max3_f32 v4, v4, v90, v91
    v_max3_f32 v36, v36, v106, v107
    v_max3_f32 v5, v5, v92, v93
    v_max3_f32 v37, v37, v108, v109
    v_max3_f32 v4, v4, v94, v95
    v_max3_f32 v36, v36, v110, v111
    v_max_f32 v4, v4, v5
    v_max_f32 v36, v36, v37
    v_mul_f32 v4, s74, v4
    v_mul_f32 v36, s74, v36
    v_pk_fma_f32 v[80:81], v[80:81], s[74:75], v[4:5] op_sel_hi:[1,1,0] neg_lo:[0,0,1] neg_hi:[0,0,1]
    v_pk_fma_f32 v[96:97], v[96:97], s[74:75], v[36:37] op_sel_hi:[1,1,0] neg_lo:[0,0,1] neg_hi:[0,0,1]
    v_pk_fma_f32 v[82:83], v[82:83], s[74:75], v[4:5] op_sel_hi:[1,1,0] neg_lo:[0,0,1] neg_hi:[0,0,1]
    v_pk_fma_f32 v[98:99], v[98:99], s[74:75], v[36:37] op_sel_hi:[1,1,0] neg_lo:[0,0,1] neg_hi:[0,0,1]
    v_pk_fma_f32 v[84:85], v[84:85], s[74:75], v[4:5] op_sel_hi:[1,1,0] neg_lo:[0,0,1] neg_hi:[0,0,1]
    v_pk_fma_f32 v[100:101], v[100:101], s[74:75], v[36:37] op_sel_hi:[1,1,0] neg_lo:[0,0,1] neg_hi:[0,0,1]
    v_pk_fma_f32 v[86:87], v[86:87], s[74:75], v[4:5] op_sel_hi:[1,1,0] neg_lo:[0,0,1] neg_hi:[0,0,1]
    v_pk_fma_f32 v[102:103], v[102:103], s[74:75], v[36:37] op_sel_hi:[1,1,0] neg_lo:[0,0,1] neg_hi:[0,0,1]
    v_pk_fma_f32 v[88:89], v[88:89], s[74:75], v[4:5] op_sel_hi:[1,1,0] neg_lo:[0,0,1] neg_hi:[0,0,1]
    v_pk_fma_f32 v[104:105], v[104:105], s[74:75], v[36:37] op_sel_hi:[1,1,0] neg_lo:[0,0,1] neg_hi:[0,0,1]
    v_pk_fma_f32 v[90:91], v[90:91], s[74:75], v[4:5] op_sel_hi:[1,1,0] neg_lo:[0,0,1] neg_hi:[0,0,1]
    v_pk_fma_f32 v[106:107], v[106:107], s[74:75], v[36:37] op_sel_hi:[1,1,0] neg_lo:[0,0,1] neg_hi:[0,0,1]
    v_pk_fma_f32 v[92:93], v[92:93], s[74:75], v[4:5] op_sel_hi:[1,1,0] neg_lo:[0,0,1] neg_hi:[0,0,1]
    v_pk_fma_f32 v[108:109], v[108:109], s[74:75], v[36:37] op_sel_hi:[1,1,0] neg_lo:[0,0,1] neg_hi:[0,0,1]
    v_pk_fma_f32 v[94:95], v[94:95], s[74:75], v[4:5] op_sel_hi:[1,1,0] neg_lo:[0,0,1] neg_hi:[0,0,1]
    v_pk_fma_f32 v[110:111], v[110:111], s[74:75], v[36:37] op_sel_hi:[1,1,0] neg_lo:[0,0,1] neg_hi:[0,0,1]
    v_exp_f32 v80, v80
    v_exp_f32 v96, v96
    v_exp_f32 v81, v81
    v_exp_f32 v97, v97
    v_exp_f32 v82, v82
    v_exp_f32 v98, v98
    v_exp_f32 v83, v83
    v_exp_f32 v99, v99
    v_exp_f32 v84, v84
    v_exp_f32 v100, v100
    v_exp_f32 v85, v85
    v_exp_f32 v101, v101
    v_exp_f32 v86, v86
    v_exp_f32 v102, v102
    v_exp_f32 v87, v87
    v_exp_f32 v103, v103
    v_exp_f32 v88, v88
    v_exp_f32 v104, v104
    v_exp_f32 v89, v89
    v_exp_f32 v105, v105
    v_exp_f32 v90, v90
    v_exp_f32 v106, v106
    v_exp_f32 v91, v91
    v_exp_f32 v107, v107
    v_exp_f32 v92, v92
    v_exp_f32 v108, v108
    v_exp_f32 v93, v93
    v_exp_f32 v109, v109
    v_exp_f32 v94, v94
    v_exp_f32 v110, v110
    v_exp_f32 v95, v95
    v_exp_f32 v111, v111
    v_pk_add_f32 v[4:5], v[80:81], v[82:83]
    v_pk_add_f32 v[36:37], v[96:97], v[98:99]
    v_pk_add_f32 v[4:5], v[4:5], v[84:85]
    v_pk_add_f32 v[36:37], v[36:37], v[100:101]
    v_pk_add_f32 v[4:5], v[4:5], v[86:87]
    v_pk_add_f32 v[36:37], v[36:37], v[102:103]
    v_pk_add_f32 v[4:5], v[4:5], v[88:89]
    v_pk_add_f32 v[36:37], v[36:37], v[104:105]
    v_pk_add_f32 v[4:5], v[4:5], v[90:91]
    v_pk_add_f32 v[36:37], v[36:37], v[106:107]
    v_pk_add_f32 v[4:5], v[4:5], v[92:93]
    v_pk_add_f32 v[36:37], v[36:37], v[108:109]
    v_pk_add_f32 v[4:5], v[4:5], v[94:95]
    v_pk_add_f32 v[36:37], v[36:37], v[110:111]
    v_add_f32 v4, v4, v5
    v_add_f32 v36, v36, v37
    v_rcp_f32 v4, v4
    v_rcp_f32 v36, v36
    v_pk_mul_f32 v[80:81], v[80:81], v[4:5] op_sel_hi:[1,0]
    v_pk_mul_f32 v[96:97], v[96:97], v[36:37] op_sel_hi:[1,0]
    v_pk_mul_f32 v[82:83], v[82:83], v[4:5] op_sel_hi:[1,0]
    v_pk_mul_f32 v[98:99], v[98:99], v[36:37] op_sel_hi:[1,0]
    v_pk_mul_f32 v[84:85], v[84:85], v[4:5] op_sel_hi:[1,0]
    v_pk_mul_f32 v[100:101], v[100:101], v[36:37] op_sel_hi:[1,0]
    v_pk_mul_f32 v[86:87], v[86:87], v[4:5] op_sel_hi:[1,0]
    v_pk_mul_f32 v[102:103], v[102:103], v[36:37] op_sel_hi:[1,0]
    v_pk_mul_f32 v[88:89], v[88:89], v[4:5] op_sel_hi:[1,0]
    v_pk_mul_f32 v[104:105], v[104:105], v[36:37] op_sel_hi:[1,0]
    v_pk_mul_f32 v[90:91], v[90:91], v[4:5] op_sel_hi:[1,0]
    v_pk_mul_f32 v[106:107], v[106:107], v[36:37] op_sel_hi:[1,0]
    v_pk_mul_f32 v[92:93], v[92:93], v[4:5] op_sel_hi:[1,0]
    v_pk_mul_f32 v[108:109], v[108:109], v[36:37] op_sel_hi:[1,0]
    v_pk_mul_f32 v[94:95], v[94:95], v[4:5] op_sel_hi:[1,0]
    v_pk_mul_f32 v[110:111], v[110:111], v[36:37] op_sel_hi:[1,0]
    v_cvt_pk_bf16_f32 v56, v80, v81
    v_cvt_pk_bf16_f32 v64, v96, v97
    v_cvt_pk_bf16_f32 v57, v82, v83
    v_cvt_pk_bf16_f32 v65, v98, v99
    v_cvt_pk_bf16_f32 v58, v84, v85
    v_cvt_pk_bf16_f32 v66, v100, v101
    v_cvt_pk_bf16_f32 v59, v86, v87
    v_cvt_pk_bf16_f32 v67, v102, v103
    v_cvt_pk_bf16_f32 v60, v88, v89
    v_cvt_pk_bf16_f32 v68, v104, v105
    v_cvt_pk_bf16_f32 v61, v90, v91
    v_cvt_pk_bf16_f32 v69, v106, v107
    v_cvt_pk_bf16_f32 v62, v92, v93
    v_cvt_pk_bf16_f32 v70, v108, v109
    v_cvt_pk_bf16_f32 v63, v94, v95
    v_cvt_pk_bf16_f32 v71, v110, v111
    v_mfma_f32_32x32x16_bf16 v[80:95], v[24:27], v[48:51], 0
    v_mfma_f32_32x32x16_bf16 v[96:111], v[24:27], v[52:55], 0
    s_waitcnt vmcnt(0)
    s_mov_b64 exec, 1
    v_mov_b32 v4, 158720
    v_mov_b32 v5, 1
    ds_add_rtn_u32 v6, v4, v5 offset:8
    s_waitcnt lgkmcnt(0)
    v_cmp_eq_u32 vcc, 7, v6
    s_cbranch_vccz F_HF1
    buffer_store_dwordx2 v[22:23], v7, s[36:39], s77 offen sc1
F_HF1:
    s_mov_b64 exec, -1
    s_barrier
    ds_read_b64_tr_b16 v[200:201], v18 offset:0
    ds_read_b64_tr_b16 v[202:203], v18 offset:1024
    ds_read_b64_tr_b16 v[204:205], v19 offset:0
    ds_read_b64_tr_b16 v[206:207], v19 offset:1024
    ds_read_b64_tr_b16 v[208:209], v18 offset:8192
    ds_read_b64_tr_b16 v[210:211], v18 offset:9216
    ds_read_b64_tr_b16 v[212:213], v19 offset:8192
    ds_read_b64_tr_b16 v[214:215], v19 offset:9216
    ds_read_b64_tr_b16 v[216:217], v16 offset:16384
    ds_read_b64_tr_b16 v[218:219], v16 offset:17408
    ds_read_b64_tr_b16 v[220:221], v17 offset:16384
    ds_read_b64_tr_b16 v[222:223], v17 offset:17408
    ds_read_b64_tr_b16 v[224:225], v16 offset:24576
    ds_read_b64_tr_b16 v[226:227], v16 offset:25600
    ds_read_b64_tr_b16 v[228:229], v17 offset:24576
    ds_read_b64_tr_b16 v[230:231], v17 offset:25600
    ds_read_b64_tr_b16 v[232:233], v18 offset:16384
    ds_read_b64_tr_b16 v[234:235], v18 offset:17408
    ds_read_b64_tr_b16 v[236:237], v19 offset:16384
    ds_read_b64_tr_b16 v[238:239], v19 offset:17408
    ds_read_b64_tr_b16 v[240:241], v18 offset:24576
    ds_read_b64_tr_b16 v[242:243], v18 offset:25600
    ds_read_b64_tr_b16 v[244:245], v19 offset:24576
    ds_read_b64_tr_b16 v[246:247], v19 offset:25600
    ds_read_b64_tr_b16 v[248:249], v18 offset:32768
    ds_read_b64_tr_b16 v[250:251], v18 offset:33792
    ds_read_b64_tr_b16 v[252:253], v19 offset:32768
    ds_read_b64_tr_b16 v[254:255], v19 offset:33792
    v_max3_f32 v4, v80, v81, v82
    v_max3_f32 v36, v96, v97, v98
    v_max3_f32 v5, v83, v84, v85
    v_max3_f32 v37, v99, v100, v101
    v_max3_f32 v4, v4, v86, v87
    v_max3_f32 v36, v36, v102, v103
    v_max3_f32 v5, v5, v88, v89
    v_max3_f32 v37, v37, v104, v105
    v_max3_f32 v4, v4, v90, v91
    v_max3_f32 v36, v36, v106, v107
    v_max3_f32 v5, v5, v92, v93
    v_max3_f32 v37, v37, v108, v109
    v_max3_f32 v4, v4, v94, v95
    v_max3_f32 v36, v36, v110, v111
    v_max_f32 v4, v4, v5
    v_max_f32 v36, v36, v37
    v_mul_f32 v4, s74, v4
    v_mul_f32 v36, s74, v36
    v_pk_fma_f32 v[80:81], v[80:81], s[74:75], v[4:5] op_sel_hi:[1,1,0] neg_lo:[0,0,1] neg_hi:[0,0,1]
    v_pk_fma_f32 v[96:97], v[96:97], s[74:75], v[36:37] op_sel_hi:[1,1,0] neg_lo:[0,0,1] neg_hi:[0,0,1]
    v_pk_fma_f32 v[82:83], v[82:83], s[74:75], v[4:5] op_sel_hi:[1,1,0] neg_lo:[0,0,1] neg_hi:[0,0,1]
    v_pk_fma_f32 v[98:99], v[98:99], s[74:75], v[36:37] op_sel_hi:[1,1,0] neg_lo:[0,0,1] neg_hi:[0,0,1]
    v_pk_fma_f32 v[84:85], v[84:85], s[74:75], v[4:5] op_sel_hi:[1,1,0] neg_lo:[0,0,1] neg_hi:[0,0,1]
    v_pk_fma_f32 v[100:101], v[100:101], s[74:75], v[36:37] op_sel_hi:[1,1,0] neg_lo:[0,0,1] neg_hi:[0,0,1]
    v_pk_fma_f32 v[86:87], v[86:87], s[74:75], v[4:5] op_sel_hi:[1,1,0] neg_lo:[0,0,1] neg_hi:[0,0,1]
    v_pk_fma_f32 v[102:103], v[102:103], s[74:75], v[36:37] op_sel_hi:[1,1,0] neg_lo:[0,0,1] neg_hi:[0,0,1]
    v_pk_fma_f32 v[88:89], v[88:89], s[74:75], v[4:5] op_sel_hi:[1,1,0] neg_lo:[0,0,1] neg_hi:[0,0,1]
    v_pk_fma_f32 v[104:105], v[104:105], s[74:75], v[36:37] op_sel_hi:[1,1,0] neg_lo:[0,0,1] neg_hi:[0,0,1]
    v_pk_fma_f32 v[90:91], v[90:91], s[74:75], v[4:5] op_sel_hi:[1,1,0] neg_lo:[0,0,1] neg_hi:[0,0,1]
    v_pk_fma_f32 v[106:107], v[106:107], s[74:75], v[36:37] op_sel_hi:[1,1,0] neg_lo:[0,0,1] neg_hi:[0,0,1]
    v_pk_fma_f32 v[92:93], v[92:93], s[74:75], v[4:5] op_sel_hi:[1,1,0] neg_lo:[0,0,1] neg_hi:[0,0,1]
    v_pk_fma_f32 v[108:109], v[108:109], s[74:75], v[36:37] op_sel_hi:[1,1,0] neg_lo:[0,0,1] neg_hi:[0,0,1]
    v_pk_fma_f32 v[94:95], v[94:95], s[74:75], v[4:5] op_sel_hi:[1,1,0] neg_lo:[0,0,1] neg_hi:[0,0,1]
    v_pk_fma_f32 v[110:111], v[110:111], s[74:75], v[36:37] op_sel_hi:[1,1,0] neg_lo:[0,0,1] neg_hi:[0,0,1]
    v_exp_f32 v80, v80
    v_exp_f32 v96, v96
    v_exp_f32 v81, v81
    v_exp_f32 v97, v97
    v_exp_f32 v82, v82
    v_exp_f32 v98, v98
    v_exp_f32 v83, v83
    v_exp_f32 v99, v99
    v_exp_f32 v84, v84
    v_exp_f32 v100, v100
    v_exp_f32 v85, v85
    v_exp_f32 v101, v101
    v_exp_f32 v86, v86
    v_exp_f32 v102, v102
    v_exp_f32 v87, v87
    v_exp_f32 v103, v103
    v_exp_f32 v88, v88
    v_exp_f32 v104, v104
    v_exp_f32 v89, v89
    v_exp_f32 v105, v105
    v_exp_f32 v90, v90
    v_exp_f32 v106, v106
    v_exp_f32 v91, v91
    v_exp_f32 v107, v107
    v_exp_f32 v92, v92
    v_exp_f32 v108, v108
    v_exp_f32 v93, v93
    v_exp_f32 v109, v109
    v_exp_f32 v94, v94
    v_exp_f32 v110, v110
    v_exp_f32 v95, v95
    v_exp_f32 v111, v111
    v_pk_add_f32 v[4:5], v[80:81], v[82:83]
    v_pk_add_f32 v[36:37], v[96:97], v[98:99]
    v_pk_add_f32 v[4:5], v[4:5], v[84:85]
    v_pk_add_f32 v[36:37], v[36:37], v[100:101]
    v_pk_add_f32 v[4:5], v[4:5], v[86:87]
    v_pk_add_f32 v[36:37], v[36:37], v[102:103]
    v_pk_add_f32 v[4:5], v[4:5], v[88:89]
    v_pk_add_f32 v[36:37], v[36:37], v[104:105]
    v_pk_add_f32 v[4:5], v[4:5], v[90:91]
    v_pk_add_f32 v[36:37], v[36:37], v[106:107]
    v_pk_add_f32 v[4:5], v[4:5], v[92:93]
    v_pk_add_f32 v[36:37], v[36:37], v[108:109]
    v_pk_add_f32 v[4:5], v[4:5], v[94:95]
    v_pk_add_f32 v[36:37], v[36:37], v[110:111]
    v_add_f32 v4, v4, v5
    v_add_f32 v36, v36, v37
    v_rcp_f32 v4, v4
    v_rcp_f32 v36, v36
    v_pk_mul_f32 v[80:81], v[80:81], v[4:5] op_sel_hi:[1,0]
    v_pk_mul_f32 v[96:97], v[96:97], v[36:37] op_sel_hi:[1,0]
    v_pk_mul_f32 v[82:83], v[82:83], v[4:5] op_sel_hi:[1,0]
    v_pk_mul_f32 v[98:99], v[98:99], v[36:37] op_sel_hi:[1,0]
    v_pk_mul_f32 v[84:85], v[84:85], v[4:5] op_sel_hi:[1,0]
    v_pk_mul_f32 v[100:101], v[100:101], v[36:37] op_sel_hi:[1,0]
    v_pk_mul_f32 v[86:87], v[86:87], v[4:5] op_sel_hi:[1,0]
    v_pk_mul_f32 v[102:103], v[102:103], v[36:37] op_sel_hi:[1,0]
    v_pk_mul_f32 v[88:89], v[88:89], v[4:5] op_sel_hi:[1,0]
    v_pk_mul_f32 v[104:105], v[104:105], v[36:37] op_sel_hi:[1,0]
    v_pk_mul_f32 v[90:91], v[90:91], v[4:5] op_sel_hi:[1,0]
    v_pk_mul_f32 v[106:107], v[106:107], v[36:37] op_sel_hi:[1,0]
    v_pk_mul_f32 v[92:93], v[92:93], v[4:5] op_sel_hi:[1,0]
    v_pk_mul_f32 v[108:109], v[108:109], v[36:37] op_sel_hi:[1,0]
    v_pk_mul_f32 v[94:95], v[94:95], v[4:5] op_sel_hi:[1,0]
    v_pk_mul_f32 v[110:111], v[110:111], v[36:37] op_sel_hi:[1,0]
    s_waitcnt lgkmcnt(0)
    s_barrier
    v_cvt_pk_bf16_f32 v72, v80, v81
    v_cvt_pk_bf16_f32 v28, v96, v97
    v_cvt_pk_bf16_f32 v73, v82, v83
    v_cvt_pk_bf16_f32 v29, v98, v99
    v_cvt_pk_bf16_f32 v74, v84, v85
    v_cvt_pk_bf16_f32 v30, v100, v101
    v_cvt_pk_bf16_f32 v75, v86, v87
    v_cvt_pk_bf16_f32 v31, v102, v103
    v_cvt_pk_bf16_f32 v76, v88, v89
    v_cvt_pk_bf16_f32 v32, v104, v105
    v_cvt_pk_bf16_f32 v77, v90, v91
    v_cvt_pk_bf16_f32 v33, v106, v107
    v_cvt_pk_bf16_f32 v78, v92, v93
    v_cvt_pk_bf16_f32 v34, v108, v109
    v_cvt_pk_bf16_f32 v79, v94, v95
    v_cvt_pk_bf16_f32 v35, v110, v111
    v_mov_b32 v5, 158720
    s_cmp_lg_u32 s60, 0
    s_cbranch_scc1 F_PKW
    buffer_load_dwordx2 v[38:39], v3, s[36:39], s22 offen sc1
    s_waitcnt vmcnt(0)
    s_mov_b32 s87, 0
F_PK_S:
    v_cmp_ne_u64 vcc, v[22:23], v[38:39]
    s_cbranch_vccz F_PK_G
    s_add_u32 s87, s87, 1
    s_cmp_ge_u32 s87, 0x10000
    s_cbranch_scc1 F_PK_G
    s_sleep 4
    buffer_load_dwordx2 v[38:39], v3, s[36:39], s22 offen sc1
    s_waitcnt vmcnt(0)
    s_branch F_PK_S
F_PK_G:
    v_mov_b32 v4, 1
    ds_write_b32 v5, v4 offset:16
F_PKW:
    s_mov_b32 s87, 0
F_PKW_S:
    ds_read_b32 v4, v5 offset:16
    s_waitcnt lgkmcnt(0)
    v_cmp_eq_u32 vcc, 0, v4
    s_cbranch_vccz F_PKW_G
    s_add_u32 s87, s87, 1
    s_cmp_ge_u32 s87, 0x1000000
    s_cbranch_scc1 F_PKW_G
    s_sleep 1
    s_branch F_PKW_S
F_PKW_G:
    buffer_load_dwordx2 v[38:39], v11, s[36:39], s70 offen sc1
    buffer_load_dword v96, v14, s[36:39], s68 offen sc1
    v_add_u32 v14, v14, v2
    buffer_load_dword v97, v14, s[36:39], s68 offen sc1
    v_add_u32 v14, v14, v2
    buffer_load_dword v98, v14, s[36:39], s68 offen sc1
    v_add_u32 v14, v14, v2
    buffer_load_dword v99, v14, s[36:39], s68 offen sc1
    v_add_u32 v14, v14, v2
    buffer_load_dword v100, v14, s[36:39], s68 offen sc1
    v_add_u32 v14, v14, v2
    buffer_load_dword v101, v14, s[36:39], s68 offen sc1
    v_add_u32 v14, v14, v2
    buffer_load_dword v102, v14, s[36:39], s68 offen sc1
    v_add_u32 v14, v14, v2
    buffer_load_dword v103, v14, s[36:39], s68 offen sc1
    v_add_u32 v14, v14, v2
    buffer_load_dword v104, v14, s[36:39], s68 offen sc1
    v_add_u32 v14, v14, v2
    buffer_load_dword v105, v14, s[36:39], s68 offen sc1
    v_add_u32 v14, v14, v2
    buffer_load_dword v106, v14, s[36:39], s68 offen sc1
    v_add_u32 v14, v14, v2
    buffer_load_dword v107, v14, s[36:39], s68 offen sc1
    v_add_u32 v14, v14, v2
    buffer_load_dword v108, v14, s[36:39], s68 offen sc1
    v_add_u32 v14, v14, v2
    buffer_load_dword v109, v14, s[36:39], s68 offen sc1
    v_add_u32 v14, v14, v2
    buffer_load_dword v110, v14, s[36:39], s68 offen sc1
    v_add_u32 v14, v14, v2
    buffer_load_dword v111, v14, s[36:39], s68 offen sc1
    s_add_u32 s68, s69, 295040
    s_waitcnt vmcnt(16)
    s_mov_b32 s87, 0
F_PHC_S:
    v_cmp_ne_u64 vcc, v[22:23], v[38:39]
    s_cbranch_vccz F_PHC_G
    s_add_u32 s87, s87, 1
    s_cmp_ge_u32 s87, 0x10000
    s_cbranch_scc1 F_PHC_G
    s_sleep 8
    buffer_load_dwordx2 v[38:39], v11, s[36:39], s70 offen sc1
    s_waitcnt vmcnt(0)
    s_branch F_PHC_S
F_PHC_G:
    buffer_load_dwordx4 v[40:43], v12, s[36:39], s85 offen offset:0 sc1
    buffer_load_dwordx4 v[44:47], v12, s[36:39], s85 offen offset:2048 sc1
    s_add_u32 s85, s85, 4096
    buffer_load_dwordx4 v[48:51], v12, s[36:39], s85 offen offset:0 sc1
    buffer_load_dwordx4 v[52:55], v12, s[36:39], s85 offen offset:2048 sc1
    s_add_u32 s85, s85, 4096
    s_waitcnt vmcnt(4)
    v_cvt_pk_bf16_f32 v96, v96, v97
    v_cvt_pk_bf16_f32 v97, v98, v99
    v_cvt_pk_bf16_f32 v98, v100, v101
    v_cvt_pk_bf16_f32 v99, v102, v103
    v_cvt_pk_bf16_f32 v100, v104, v105
    v_cvt_pk_bf16_f32 v101, v106, v107
    v_cvt_pk_bf16_f32 v102, v108, v109
    v_cvt_pk_bf16_f32 v103, v110, v111
    v_mfma_f32_32x32x16_bf16 v[80:95], v[96:99], v[56:59], 0
    s_nop 0
    v_mfma_f32_32x32x16_bf16 v[80:95], v[100:103], v[60:63], v[80:95]
    s_nop 11
    v_add_f32 v4, 0x358637bd, v88
    v_rcp_f32 v4, v4
    s_nop 0
    v_mul_f32 v80, v80, v4
    v_mul_f32 v81, v81, v4
    v_mul_f32 v82, v82, v4
    v_mul_f32 v83, v83, v4
    v_mul_f32 v84, v84, v4
    v_mul_f32 v85, v85, v4
    v_mul_f32 v86, v86, v4
    v_mul_f32 v87, v87, v4
    v_cvt_pk_bf16_f32 v56, v80, v81
    v_cvt_pk_bf16_f32 v57, v82, v83
    v_cvt_pk_bf16_f32 v58, v84, v85
    v_cvt_pk_bf16_f32 v59, v86, v87
    buffer_store_dwordx4 v[56:59], v12, s[36:39], s69 offen offset:0 sc1
    v_mfma_f32_32x32x16_bf16 v[80:95], v[96:99], v[64:67], 0
    v_mfma_f32_32x32x16_bf16 v[80:95], v[100:103], v[68:71], v[80:95]
    s_nop 11
    v_add_f32 v4, 0x358637bd, v88
    v_rcp_f32 v4, v4
    s_nop 0
    v_mul_f32 v80, v80, v4
    v_mul_f32 v81, v81, v4
    v_mul_f32 v82, v82, v4
    v_mul_f32 v83, v83, v4
    v_mul_f32 v84, v84, v4
    v_mul_f32 v85, v85, v4
    v_mul_f32 v86, v86, v4
    v_mul_f32 v87, v87, v4
    v_cvt_pk_bf16_f32 v64, v80, v81
    v_cvt_pk_bf16_f32 v65, v82, v83
    v_cvt_pk_bf16_f32 v66, v84, v85
    v_cvt_pk_bf16_f32 v67, v86, v87
    buffer_store_dwordx4 v[64:67], v12, s[36:39], s69 offen offset:1024 sc1
    v_mfma_f32_32x32x16_bf16 v[80:95], v[96:99], v[72:75], 0
    v_mfma_f32_32x32x16_bf16 v[80:95], v[100:103], v[76:79], v[80:95]
    s_nop 11
    v_add_f32 v4, 0x358637bd, v88
    v_rcp_f32 v4, v4
    s_nop 0
    v_mul_f32 v80, v80, v4
    v_mul_f32 v81, v81, v4
    v_mul_f32 v82, v82, v4
    v_mul_f32 v83, v83, v4
    v_mul_f32 v84, v84, v4
    v_mul_f32 v85, v85, v4
    v_mul_f32 v86, v86, v4
    v_mul_f32 v87, v87, v4
    v_cvt_pk_bf16_f32 v72, v80, v81
    v_cvt_pk_bf16_f32 v73, v82, v83
    v_cvt_pk_bf16_f32 v74, v84, v85
    v_cvt_pk_bf16_f32 v75, v86, v87
    buffer_store_dwordx4 v[72:75], v12, s[36:39], s68 offen offset:0 sc1
    v_mfma_f32_32x32x16_bf16 v[80:95], v[96:99], v[28:31], 0
    v_mfma_f32_32x32x16_bf16 v[80:95], v[100:103], v[32:35], v[80:95]
    s_nop 11
    v_add_f32 v4, 0x358637bd, v88
    v_rcp_f32 v4, v4
    s_nop 0
    v_mul_f32 v80, v80, v4
    v_mul_f32 v81, v81, v4
    v_mul_f32 v82, v82, v4
    v_mul_f32 v83, v83, v4
    v_mul_f32 v84, v84, v4
    v_mul_f32 v85, v85, v4
    v_mul_f32 v86, v86, v4
    v_mul_f32 v87, v87, v4
    v_cvt_pk_bf16_f32 v28, v80, v81
    v_cvt_pk_bf16_f32 v29, v82, v83
    v_cvt_pk_bf16_f32 v30, v84, v85
    v_cvt_pk_bf16_f32 v31, v86, v87
    buffer_store_dwordx4 v[28:31], v12, s[36:39], s68 offen offset:1024 sc1
    s_setprio 0
    s_branch F_MAINC
F_HL:
    s_add_u32 m0, s24, 15360
    s_add_u32 s20, s23, 204800
    buffer_load_dwordx4 v15, s[44:47], s20 offen lds
    s_add_u32 m0, s24, 16384
    s_add_u32 s20, s23, 212992
    buffer_load_dwordx4 v15, s[44:47], s20 offen lds
    s_add_u32 m0, s24, 23552
    s_add_u32 s20, s23, 221184
    buffer_load_dwordx4 v15, s[44:47], s20 offen lds
    s_add_u32 m0, s24, 24576
    s_add_u32 s20, s23, 229376
    buffer_load_dwordx4 v15, s[44:47], s20 offen lds
    ds_read_b64_tr_b16 v[112:113], v20 offset:16384
    ds_read_b64_tr_b16 v[114:115], v20 offset:17408
    ds_read_b64_tr_b16 v[116:117], v21 offset:16384
    ds_read_b64_tr_b16 v[118:119], v21 offset:17408
    ds_read_b64_tr_b16 v[120:121], v16 offset:32768
    ds_read_b64_tr_b16 v[122:123], v16 offset:33792
    ds_read_b64_tr_b16 v[124:125], v17 offset:32768
    ds_read_b64_tr_b16 v[126:127], v17 offset:33792
    ds_read_b64_tr_b16 v[128:129], v16 offset:40960
    ds_read_b64_tr_b16 v[130:131], v16 offset:41984
    ds_read_b64_tr_b16 v[132:133], v17 offset:40960
    ds_read_b64_tr_b16 v[134:135], v17 offset:41984
    ds_read_b64_tr_b16 v[136:137], v18 offset:49152
    ds_read_b64_tr_b16 v[138:139], v18 offset:50176
    ds_read_b64_tr_b16 v[140:141], v19 offset:49152
    ds_read_b64_tr_b16 v[142:143], v19 offset:50176
    ds_read_b64_tr_b16 v[144:145], v18 offset:57344
    ds_read_b64_tr_b16 v[146:147], v18 offset:58368
    ds_read_b64_tr_b16 v[148:149], v19 offset:57344
    ds_read_b64_tr_b16 v[150:151], v19 offset:58368
    ds_read_b64_tr_b16 v[152:153], v20 offset:0
    ds_read_b64_tr_b16 v[154:155], v20 offset:1024
    ds_read_b64_tr_b16 v[156:157], v21 offset:0
    ds_read_b64_tr_b16 v[158:159], v21 offset:1024
    ds_read_b64_tr_b16 v[160:161], v20 offset:8192
    ds_read_b64_tr_b16 v[162:163], v20 offset:9216
    ds_read_b64_tr_b16 v[164:165], v21 offset:8192
    ds_read_b64_tr_b16 v[166:167], v21 offset:9216
    ds_read_b64_tr_b16 v[168:169], v16 offset:0
    ds_read_b64_tr_b16 v[170:171], v16 offset:1024
    ds_read_b64_tr_b16 v[172:173], v17 offset:0
    ds_read_b64_tr_b16 v[174:175], v17 offset:1024
    ds_read_b64_tr_b16 v[176:177], v16 offset:8192
    ds_read_b64_tr_b16 v[178:179], v16 offset:9216
    ds_read_b64_tr_b16 v[180:181], v17 offset:8192
    ds_read_b64_tr_b16 v[182:183], v17 offset:9216
    ds_read_b64_tr_b16 v[184:185], v16 offset:49152
    ds_read_b64_tr_b16 v[186:187], v16 offset:50176
    ds_read_b64_tr_b16 v[188:189], v17 offset:49152
    ds_read_b64_tr_b16 v[190:191], v17 offset:50176
    ds_read_b64_tr_b16 v[192:193], v16 offset:57344
    ds_read_b64_tr_b16 v[194:195], v16 offset:58368
    ds_read_b64_tr_b16 v[196:197], v17 offset:57344
    ds_read_b64_tr_b16 v[198:199], v17 offset:58368
    s_add_u32 m0, s24, 80896
    s_add_u32 s20, s23, 237568
    buffer_load_dwordx4 v15, s[44:47], s20 offen lds
    s_add_u32 m0, s24, 81920
    s_add_u32 s20, s23, 245760
    buffer_load_dwordx4 v15, s[44:47], s20 offen lds
    s_add_u32 m0, s24, 89088
    s_add_u32 s20, s23, 253952
    buffer_load_dwordx4 v15, s[44:47], s20 offen lds
    s_add_u32 m0, s24, 90112
    s_add_u32 s20, s23, 262144
    buffer_load_dwordx4 v15, s[44:47], s20 offen lds
    s_add_u32 m0, s24, 97280
    s_add_u32 s20, s23, 270336
    buffer_load_dwordx4 v15, s[44:47], s20 offen lds
    s_add_u32 m0, s24, 98304
    s_add_u32 s20, s23, 278528
    buffer_load_dwordx4 v15, s[44:47], s20 offen lds
    s_waitcnt lgkmcnt(0)
    s_barrier
    s_add_u32 m0, s24, 64512
    s_add_u32 s20, s23, 172032
    buffer_load_dwordx4 v15, s[44:47], s20 offen lds
    s_add_u32 m0, s24, 65536
    s_add_u32 s20, s23, 180224
    buffer_load_dwordx4 v15, s[44:47], s20 offen lds
    s_add_u32 m0, s24, 72704
    s_add_u32 s20, s23, 188416
    buffer_load_dwordx4 v15, s[44:47], s20 offen lds
    s_add_u32 m0, s24, 73728
    s_add_u32 s20, s23, 196608
    buffer_load_dwordx4 v15, s[44:47], s20 offen lds
    s_add_u32 m0, s24, 146432
    s_add_u32 s20, s23, 286720
    buffer_load_dwordx4 v15, s[44:47], s20 offen lds
    s_add_u32 m0, s24, 147456
    s_add_u32 s20, s23, 294912
    buffer_load_dwordx4 v15, s[44:47], s20 offen lds
    s_add_u32 m0, s24, 31744
    s_add_u32 s20, s23, 303104
    buffer_load_dwordx4 v15, s[44:47], s20 offen lds
    s_add_u32 m0, s24, 32768
    s_add_u32 s20, s23, 311296
    buffer_load_dwordx4 v15, s[44:47], s20 offen lds
    s_waitcnt vmcnt(18)
    s_mov_b64 exec, 1
    v_mov_b32 v4, 158720
    v_mov_b32 v5, 1
    ds_add_rtn_u32 v6, v4, v5 offset:8
    s_waitcnt lgkmcnt(0)
    v_cmp_eq_u32 vcc, 7, v6
    s_cbranch_vccz F_HF1L
    buffer_store_dwordx2 v[22:23], v7, s[36:39], s77 offen sc1
F_HF1L:
    s_mov_b64 exec, -1
    s_add_u32 m0, s24, 39936
    s_add_u32 s20, s23, 319488
    buffer_load_dwordx4 v15, s[44:47], s20 offen lds
    s_add_u32 m0, s24, 40960
    s_add_u32 s20, s23, 327680
    buffer_load_dwordx4 v15, s[44:47], s20 offen lds
    s_add_u32 m0, s24, 113664
    s_add_u32 s20, s23, 335872
    buffer_load_dwordx4 v15, s[44:47], s20 offen lds
    s_add_u32 m0, s24, 114688
    s_add_u32 s20, s23, 344064
    buffer_load_dwordx4 v15, s[44:47], s20 offen lds
    s_add_u32 m0, s24, 121856
    s_add_u32 s20, s23, 352256
    buffer_load_dwordx4 v15, s[44:47], s20 offen lds
    s_add_u32 m0, s24, 122880
    s_add_u32 s20, s23, 360448
    buffer_load_dwordx4 v15, s[44:47], s20 offen lds
    s_add_u32 m0, s24, 130048
    s_add_u32 s20, s23, 368640
    buffer_load_dwordx4 v15, s[44:47], s20 offen lds
    s_add_u32 m0, s24, 131072
    s_add_u32 s20, s23, 376832
    buffer_load_dwordx4 v15, s[44:47], s20 offen lds
    s_add_u32 m0, s24, 138240
    s_add_u32 s20, s23, 385024
    buffer_load_dwordx4 v15, s[44:47], s20 offen lds
    s_add_u32 m0, s24, 139264
    s_add_u32 s20, s23, 393216
    buffer_load_dwordx4 v15, s[44:47], s20 offen lds
    s_waitcnt vmcnt(14)
    s_barrier
    ds_read_b64_tr_b16 v[200:201], v18 offset:0
    ds_read_b64_tr_b16 v[202:203], v18 offset:1024
    ds_read_b64_tr_b16 v[204:205], v19 offset:0
    ds_read_b64_tr_b16 v[206:207], v19 offset:1024
    ds_read_b64_tr_b16 v[208:209], v18 offset:8192
    ds_read_b64_tr_b16 v[210:211], v18 offset:9216
    ds_read_b64_tr_b16 v[212:213], v19 offset:8192
    ds_read_b64_tr_b16 v[214:215], v19 offset:9216
    ds_read_b64_tr_b16 v[216:217], v16 offset:16384
    ds_read_b64_tr_b16 v[218:219], v16 offset:17408
    ds_read_b64_tr_b16 v[220:221], v17 offset:16384
    ds_read_b64_tr_b16 v[222:223], v17 offset:17408
    ds_read_b64_tr_b16 v[224:225], v16 offset:24576
    ds_read_b64_tr_b16 v[226:227], v16 offset:25600
    ds_read_b64_tr_b16 v[228:229], v17 offset:24576
    ds_read_b64_tr_b16 v[230:231], v17 offset:25600
    ds_read_b64_tr_b16 v[232:233], v18 offset:16384
    ds_read_b64_tr_b16 v[234:235], v18 offset:17408
    ds_read_b64_tr_b16 v[236:237], v19 offset:16384
    ds_read_b64_tr_b16 v[238:239], v19 offset:17408
    ds_read_b64_tr_b16 v[240:241], v18 offset:24576
    ds_read_b64_tr_b16 v[242:243], v18 offset:25600
    ds_read_b64_tr_b16 v[244:245], v19 offset:24576
    ds_read_b64_tr_b16 v[246:247], v19 offset:25600
    ds_read_b64_tr_b16 v[248:249], v18 offset:32768
    ds_read_b64_tr_b16 v[250:251], v18 offset:33792
    ds_read_b64_tr_b16 v[252:253], v19 offset:32768
    ds_read_b64_tr_b16 v[254:255], v19 offset:33792
    s_add_u32 m0, s24, 4294966272
    s_add_u32 s20, s23, 401408
    buffer_load_dwordx4 v15, s[44:47], s20 offen lds
    s_add_u32 m0, s24, 0
    s_add_u32 s20, s23, 409600
    buffer_load_dwordx4 v15, s[44:47], s20 offen lds
    s_add_u32 m0, s24, 7168
    s_add_u32 s20, s23, 417792
    buffer_load_dwordx4 v15, s[44:47], s20 offen lds
    s_add_u32 m0, s24, 8192
    s_add_u32 s20, s23, 425984
    buffer_load_dwordx4 v15, s[44:47], s20 offen lds
    s_add_u32 m0, s24, 48128
    s_add_u32 s20, s23, 434176
    buffer_load_dwordx4 v15, s[44:47], s20 offen lds
    s_add_u32 m0, s24, 49152
    s_add_u32 s20, s23, 442368
    buffer_load_dwordx4 v15, s[44:47], s20 offen lds
    s_add_u32 m0, s24, 56320
    s_add_u32 s20, s25, 4294959104
    buffer_load_dwordx4 v15, s[48:51], s20 offen lds
    s_add_u32 m0, s24, 57344
    s_add_u32 s20, s25, 0
    buffer_load_dwordx4 v15, s[48:51], s20 offen lds
    s_waitcnt lgkmcnt(0)
    s_barrier
    s_add_u32 m0, s24, 64512
    s_add_u32 s20, s25, 8192
    buffer_load_dwordx4 v15, s[48:51], s20 offen lds
    s_add_u32 m0, s24, 65536
    s_add_u32 s20, s25, 16384
    buffer_load_dwordx4 v15, s[48:51], s20 offen lds
    s_add_u32 m0, s24, 72704
    s_add_u32 s20, s25, 24576
    buffer_load_dwordx4 v15, s[48:51], s20 offen lds
    s_add_u32 m0, s24, 73728
    s_add_u32 s20, s25, 32768
    buffer_load_dwordx4 v15, s[48:51], s20 offen lds
    s_add_u32 m0, s24, 15360
    s_add_u32 s20, s25, 40960
    buffer_load_dwordx4 v15, s[48:51], s20 offen lds
    s_add_u32 m0, s24, 16384
    s_add_u32 s20, s25, 49152
    buffer_load_dwordx4 v15, s[48:51], s20 offen lds
    s_add_u32 m0, s24, 23552
    s_add_u32 s20, s25, 57344
    buffer_load_dwordx4 v15, s[48:51], s20 offen lds
    s_add_u32 m0, s24, 24576
    s_add_u32 s20, s25, 65536
    buffer_load_dwordx4 v15, s[48:51], s20 offen lds
    s_add_u32 m0, s24, 80896
    s_add_u32 s20, s25, 73728
    buffer_load_dwordx4 v15, s[48:51], s20 offen lds
    s_add_u32 m0, s24, 81920
    s_add_u32 s20, s25, 81920
    buffer_load_dwordx4 v15, s[48:51], s20 offen lds
    buffer_load_dwordx2 v[38:39], v11, s[36:39], s70 offen sc1
    s_add_u32 m0, s24, 89088
    s_add_u32 s20, s25, 90112
    buffer_load_dwordx4 v15, s[48:51], s20 offen lds
    s_add_u32 m0, s24, 90112
    s_add_u32 s20, s25, 98304
    buffer_load_dwordx4 v15, s[48:51], s20 offen lds
    s_add_u32 m0, s24, 97280
    s_add_u32 s20, s25, 106496
    buffer_load_dwordx4 v15, s[48:51], s20 offen lds
    s_add_u32 m0, s24, 98304
    s_add_u32 s20, s25, 114688
    buffer_load_dwordx4 v15, s[48:51], s20 offen lds
    s_mov_b32 s88, 2
    s_waitcnt vmcnt(4)
    s_branch F_MAIN
F_KV:
    s_mov_b32 s38, 16777216
    s_mov_b32 s39, 0x00020000
    s_mov_b32 s42, 16384
    s_mov_b32 s43, 0x00020000
    s_mov_b32 s46, 1835008
    s_mov_b32 s47, 0x00020000
    s_mov_b32 s50, 524288
    s_mov_b32 s51, 0x00020000
    s_mov_b32 s54, 2097152
    s_mov_b32 s55, 0x00020000
    s_mov_b32 s58, 256
    s_mov_b32 s59, 0x00020000
    s_mov_b32 s10, 1024
    s_mov_b32 s11, 0x00020000
    s_lshl_b32 s79, s81, 2
    s_lshr_b32 s3, s82, 3
    s_add_u32 s79, s79, s3
    s_add_u32 s80, s82, 1
    s_and_b32 s80, s80, 3
    s_lshr_b32 s3, s82, 1
    s_and_b32 s3, s3, 4
    s_cmp_eq_u32 s80, 3
    s_cselect_b32 s3, 0, s3
    s_and_b32 s26, s82, 4
    s_xor_b32 s3, s3, s26
    s_add_u32 s80, s80, s3
    s_and_b32 s83, s60, 3
    s_lshr_b32 s84, s60, 2
    s_mov_b32 s74, 1069066811
    s_mov_b32 s75, 1069066811
    v_and_b32 v8, 31, v0
    v_lshrrev_b32 v9, 5, v0
    v_bfe_u32 v10, v0, 2, 2
    v_bfe_u32 v4, v0, 4, 1
    v_and_b32 v5, 3, v0
    v_lshlrev_b32 v5, 3, v5
    v_lshl_add_u32 v11, v4, 5, v5
    v_lshlrev_b32 v12, 4, v0
    v_mov_b32 v7, 0
    v_lshrrev_b32 v5, 3, v0
    v_lshlrev_b32 v4, 2, v4
    v_and_b32 v6, 7, v0
    v_xor_b32 v4, v4, v6
    v_lshlrev_b32 v4, 4, v4
    v_lshl_add_u32 v15, v5, 10, v4
    s_lshl_b32 s26, s80, 7
    s_lshl_b32 s3, s84, 13
    s_add_u32 s26, s26, s3
    s_mul_i32 s3, s83, 458752
    s_add_u32 s23, s26, s3
    s_lshl_b32 s3, s83, 17
    s_add_u32 s25, s26, s3
    s_lshr_b32 s100, s82, 3
    s_mov_b32 s100, 0
    s_mul_i32 s3, s100, 114688
    s_add_u32 s23, s23, s3
    s_sub_u32 s101, s23, 458752
    s_lshl_b32 s24, s83, 11
    s_lshl_b32 s3, s84, 10
    s_add_u32 s24, s24, s3
    v_lshlrev_b32 v4, 2, v0
    v_add_u32 v4, 158720, v4
    ds_write_b32 v4, v7
    v_mov_b32 v22, 0
    s_lshl_b32 s22, s62, 11
    s_lshl_b32 s3, s61, 7
    s_add_u32 s22, s22, s3
    s_add_u32 s22, s22, 14745600
    s_lshl_b32 s77, s61, 11
    s_lshl_b32 s3, s62, 7
    s_add_u32 s77, s77, s3
    s_add_u32 s77, s77, 14763008
    s_lshl_b32 s3, s83, 12
    v_bfe_u32 v4, v8, 1, 3
    v_lshlrev_b32 v5, 7, v8
    v_add_u32 v5, s3, v5
    v_add_u32 v6, 0, v9
    v_xor_b32 v6, v6, v4
    v_lshl_add_u32 v16, v6, 4, v5
    v_add_u32 v6, 2, v9
    v_xor_b32 v6, v6, v4
    v_lshl_add_u32 v17, v6, 4, v5
    v_add_u32 v6, 4, v9
    v_xor_b32 v6, v6, v4
    v_lshl_add_u32 v18, v6, 4, v5
    v_add_u32 v6, 6, v9
    v_xor_b32 v6, v6, v4
    v_lshl_add_u32 v19, v6, 4, v5
    v_lshl_add_u32 v4, v9, 3, v10
    v_lshlrev_b32 v6, 7, v4
    v_add_u32 v6, v6, v11
    v_lshrrev_b32 v5, 1, v10
    v_xor_b32 v5, s84, v5
    v_lshl_add_u32 v6, v5, 6, v6
    v_add_u32 v20, 49152, v6
    v_lshl_add_u32 v4, v4, 6, v11
    v_add_u32 v21, 98304, v4
    v_lshrrev_b32 v4, 2, v0
    v_mul_u32_u24 v4, 3584, v4
    v_and_b32 v5, 3, v0
    v_lshl_add_u32 v13, v5, 4, v4
    s_add_u32 s3, s76, s60
    s_sub_u32 s26, s3, 7
    s_cmp_ge_u32 s3, 8
    s_cselect_b32 s3, s26, s3
    s_cmp_eq_u32 s60, 0
    s_cselect_b32 s3, 0, s3
    s_mul_i32 s3, s3, 229376
    s_lshl_b32 s26, s62, 6
    s_add_u32 s3, s3, s26
    s_lshr_b32 s26, s62, 1
    s_mul_i32 s26, s26, 768
    s_add_u32 s3, s3, s26
    s_add_u32 s70, s3, 768
    s_lshl_b32 s3, s62, 2
    s_add_u32 s3, s3, s83
    s_mul_i32 s3, s3, 2304
    s_add_u32 s71, s3, 10485760
    s_lshl_b32 s3, s61, 1
    s_lshr_b32 s27, s83, 1
    s_add_u32 s3, s3, s27
    s_mul_i32 s3, s3, 295040
    s_lshl_b32 s26, s62, 12
    s_add_u32 s3, s3, s26
    s_lshl_b32 s26, s87, 10
    s_add_u32 s3, s3, s26
    s_lshr_b32 s26, s62, 1
    s_mul_i32 s26, s26, 49152
    s_add_u32 s3, s3, s26
    s_add_u32 s72, s3, 49152
    s_getpc_b64 s[12:13]
F_PC0:
    s_sub_u32 s12, s12, F_PC0 - gated_mix__linear_kernel_hedgehog__dense_activation_relu__prompt_kernel
    s_subb_u32 s13, s13, 0
    s_mov_b32 s14, F_CODE_END - gated_mix__linear_kernel_hedgehog__dense_activation_relu__prompt_kernel
    s_mov_b32 s15, 0x00020000
    s_waitcnt lgkmcnt(0)
    s_and_b32 s3, s82, 7
    s_lshl_b32 s3, s3, 3
    s_add_u32 s73, s3, s60
    s_cmp_lg_u32 s73, 999
    s_cbranch_scc1 F_N6
    v_lshlrev_b32 v4, 6, v0
    s_lshr_b32 s3, s82, 3
    s_lshl_b32 s3, s3, 13
    v_add_u32 v4, s3, v4
    buffer_load_dword v14, v4, s[12:15], 0 offen
    v_add_u32 v4, 4096, v4
    buffer_load_dword v14, v4, s[12:15], 0 offen
F_N6:
    s_cmp_lg_u32 s73, 7
    s_cbranch_scc1 F_N7
    v_mov_b32 v120, 0
    v_mov_b32 v121, 0
    v_mov_b32 v122, 0
    v_mov_b32 v123, 0
    s_lshl_b32 s3, s81, 2
    s_lshr_b32 s26, s82, 3
    s_add_u32 s3, s3, s26
    s_mul_i32 s3, s3, 2304
    s_add_u32 s3, s3, 10485760
    buffer_store_dwordx4 v[120:123], v12, s[36:39], s3 offen sc1
    buffer_store_dwordx4 v[120:123], v12, s[36:39], s3 offen offset:1024 sc1
    s_mov_b64 exec, 0xffff
    buffer_store_dwordx4 v[120:123], v12, s[36:39], s3 offen offset:2048 sc1
    s_mov_b64 exec, -1
F_N7:
    s_add_u32 s88, s88, 1
    s_cmp_eq_u32 s88, 8
    s_cselect_b32 s3, -6, 1
    s_lshl_b32 s16, s3, 7
    s_mul_i32 s18, s3, 196608
    s_add_u32 m0, s63, 16384
    s_nop 0
    buffer_load_dwordx4 v2, s[28:31], s64 offen lds
    s_add_u32 s64, s64, s16
    s_add_u32 m0, s63, 24576
    s_nop 0
    buffer_load_dwordx4 v2, s[28:31], s65 offen lds
    s_add_u32 s65, s65, s16
    s_add_u32 m0, s63, 65536
    s_nop 0
    buffer_load_dwordx4 v3, s[32:35], s66 offen lds
    s_add_u32 s66, s66, s18
    s_add_u32 m0, s63, 73728
    s_nop 0
    buffer_load_dwordx4 v3, s[32:35], s67 offen lds
    s_add_u32 s67, s67, s18
    s_waitcnt vmcnt(4) lgkmcnt(0)
    s_barrier
    ds_read_b128 v[128:131], v16 offset:0
    ds_read_b64_tr_b16 v[40:41], v20 offset:0
    ds_read_b64_tr_b16 v[42:43], v20 offset:512
    ds_read_b64_tr_b16 v[44:45], v20 offset:8192
    ds_read_b64_tr_b16 v[46:47], v20 offset:8704
    ds_read_b128 v[132:135], v17 offset:0
    ds_read_b64_tr_b16 v[48:49], v20 offset:2048
    ds_read_b64_tr_b16 v[50:51], v20 offset:2560
    ds_read_b64_tr_b16 v[52:53], v20 offset:10240
    ds_read_b64_tr_b16 v[54:55], v20 offset:10752
    s_waitcnt lgkmcnt(5)
    v_mfma_f32_32x32x16_bf16 v[64:79], v[40:43], v[128:131], 0
    ds_read_b128 v[136:139], v18 offset:0
    ds_read_b64_tr_b16 v[56:57], v20 offset:4096
    ds_read_b64_tr_b16 v[58:59], v20 offset:4608
    ds_read_b64_tr_b16 v[60:61], v20 offset:12288
    ds_read_b64_tr_b16 v[62:63], v20 offset:12800
    v_mfma_f32_32x32x16_bf16 v[80:95], v[128:131], v[44:47], 0
    ds_read_b128 v[140:143], v19 offset:0
    ds_read_b64_tr_b16 v[96:97], v20 offset:6144
    ds_read_b64_tr_b16 v[98:99], v20 offset:6656
    ds_read_b64_tr_b16 v[100:101], v20 offset:14336
    ds_read_b64_tr_b16 v[102:103], v20 offset:14848
    s_add_u32 s88, s88, 1
    s_cmp_eq_u32 s88, 8
    s_cselect_b32 s3, -6, 1
    s_lshl_b32 s16, s3, 7
    s_mul_i32 s18, s3, 196608
    s_add_u32 m0, s63, 32768
    s_nop 0
    buffer_load_dwordx4 v2, s[28:31], s64 offen lds
    s_add_u32 s64, s64, s16
    s_add_u32 m0, s63, 40960
    s_nop 0
    buffer_load_dwordx4 v2, s[28:31], s65 offen lds
    s_add_u32 s65, s65, s16
    s_waitcnt lgkmcnt(10)
    v_mfma_f32_32x32x16_bf16 v[64:79], v[48:51], v[132:135], v[64:79]
    s_add_u32 m0, s63, 81920
    s_nop 0
    buffer_load_dwordx4 v3, s[32:35], s66 offen lds
    s_add_u32 s66, s66, s18
    v_mfma_f32_32x32x16_bf16 v[80:95], v[132:135], v[52:55], v[80:95]
    s_add_u32 m0, s63, 90112
    s_nop 0
    buffer_load_dwordx4 v3, s[32:35], s67 offen lds
    s_add_u32 s67, s67, s18
    s_waitcnt lgkmcnt(5)
    v_mfma_f32_32x32x16_bf16 v[64:79], v[56:59], v[136:139], v[64:79]
    s_waitcnt vmcnt(4) lgkmcnt(0)
    s_barrier
    v_mfma_f32_32x32x16_bf16 v[80:95], v[136:139], v[60:63], v[80:95]
    ds_read_b128 v[144:147], v16 offset:16384
    ds_read_b64_tr_b16 v[104:105], v20 offset:16384
    ds_read_b64_tr_b16 v[106:107], v20 offset:16896
    ds_read_b64_tr_b16 v[108:109], v20 offset:24576
    ds_read_b64_tr_b16 v[110:111], v20 offset:25088
    s_add_u32 s88, s88, 1
    s_cmp_eq_u32 s88, 8
    s_cselect_b32 s3, -6, 1
    s_lshl_b32 s16, s3, 7
    s_mul_i32 s18, s3, 196608
    s_add_u32 m0, s63, 0
    s_nop 0
    buffer_load_dwordx4 v2, s[28:31], s64 offen lds
    s_add_u32 s64, s64, s16
    s_add_u32 m0, s63, 8192
    s_nop 0
    buffer_load_dwordx4 v2, s[28:31], s65 offen lds
    s_add_u32 s65, s65, s16
    v_mfma_f32_32x32x16_bf16 v[64:79], v[96:99], v[140:143], v[64:79]
    ds_read_b128 v[148:151], v17 offset:16384
    ds_read_b64_tr_b16 v[112:113], v20 offset:18432
    ds_read_b64_tr_b16 v[114:115], v20 offset:18944
    v_mfma_f32_32x32x16_bf16 v[80:95], v[140:143], v[100:103], v[80:95]
    ds_read_b64_tr_b16 v[116:117], v20 offset:26624
    ds_read_b64_tr_b16 v[118:119], v20 offset:27136
    s_add_u32 m0, s63, 49152
    s_nop 0
    buffer_load_dwordx4 v3, s[32:35], s66 offen lds
    s_add_u32 s66, s66, s18
    s_add_u32 m0, s63, 57344
    s_nop 0
    buffer_load_dwordx4 v3, s[32:35], s67 offen lds
    s_add_u32 s67, s67, s18
    s_cmp_lg_u32 s73, 7
    s_cbranch_scc1 F_E1
    s_waitcnt vmcnt(12)
    s_mov_b64 exec, 1
    v_mov_b32 v124, 1
    buffer_atomic_add v124, v7, s[56:59], 0 offen offset:128 sc0 sc1
    s_mov_b64 exec, -1
F_E1:
    s_waitcnt lgkmcnt(5)
    v_mfma_f32_32x32x16_bf16 v[64:79], v[104:107], v[144:147], v[64:79]
    ds_read_b128 v[152:155], v18 offset:16384
    ds_read_b64_tr_b16 v[40:41], v20 offset:20480
    ds_read_b64_tr_b16 v[42:43], v20 offset:20992
    v_mfma_f32_32x32x16_bf16 v[80:95], v[144:147], v[108:111], v[80:95]
    ds_read_b64_tr_b16 v[44:45], v20 offset:28672
    ds_read_b64_tr_b16 v[46:47], v20 offset:29184
    s_waitcnt lgkmcnt(5)
    v_mfma_f32_32x32x16_bf16 v[64:79], v[112:115], v[148:151], v[64:79]
    ds_read_b128 v[156:159], v19 offset:16384
    ds_read_b64_tr_b16 v[48:49], v20 offset:22528
    ds_read_b64_tr_b16 v[50:51], v20 offset:23040
    v_mfma_f32_32x32x16_bf16 v[80:95], v[148:151], v[116:119], v[80:95]
    ds_read_b64_tr_b16 v[52:53], v20 offset:30720
    ds_read_b64_tr_b16 v[54:55], v20 offset:31232
    s_waitcnt lgkmcnt(5)
    v_mfma_f32_32x32x16_bf16 v[64:79], v[40:43], v[152:155], v[64:79]
    s_waitcnt vmcnt(4) lgkmcnt(0)
    s_barrier
    v_mfma_f32_32x32x16_bf16 v[80:95], v[152:155], v[44:47], v[80:95]
    ds_read_b128 v[160:163], v16 offset:32768
    ds_read_b64_tr_b16 v[56:57], v20 offset:32768
    ds_read_b64_tr_b16 v[58:59], v20 offset:33280
    ds_read_b64_tr_b16 v[60:61], v20 offset:40960
    ds_read_b64_tr_b16 v[62:63], v20 offset:41472
    s_add_u32 s88, s88, 1
    s_cmp_eq_u32 s88, 8
    s_cselect_b32 s3, -6, 1
    s_lshl_b32 s16, s3, 7
    s_mul_i32 s18, s3, 196608
    s_add_u32 m0, s63, 16384
    s_nop 0
    buffer_load_dwordx4 v2, s[28:31], s64 offen lds
    s_add_u32 s64, s64, s16
    s_add_u32 m0, s63, 24576
    s_nop 0
    buffer_load_dwordx4 v2, s[28:31], s65 offen lds
    s_add_u32 s65, s65, s16
    v_mfma_f32_32x32x16_bf16 v[64:79], v[48:51], v[156:159], v[64:79]
    ds_read_b128 v[164:167], v17 offset:32768
    ds_read_b64_tr_b16 v[96:97], v20 offset:34816
    ds_read_b64_tr_b16 v[98:99], v20 offset:35328
    v_mfma_f32_32x32x16_bf16 v[80:95], v[156:159], v[52:55], v[80:95]
    ds_read_b64_tr_b16 v[100:101], v20 offset:43008
    ds_read_b64_tr_b16 v[102:103], v20 offset:43520
    s_add_u32 m0, s63, 65536
    s_nop 0
    buffer_load_dwordx4 v3, s[32:35], s66 offen lds
    s_add_u32 s66, s66, s18
    s_add_u32 m0, s63, 73728
    s_nop 0
    buffer_load_dwordx4 v3, s[32:35], s67 offen lds
    s_add_u32 s67, s67, s18
    s_waitcnt lgkmcnt(5)
    v_mfma_f32_32x32x16_bf16 v[64:79], v[56:59], v[160:163], v[64:79]
    ds_read_b128 v[168:171], v18 offset:32768
    ds_read_b64_tr_b16 v[104:105], v20 offset:36864
    ds_read_b64_tr_b16 v[106:107], v20 offset:37376
    v_mfma_f32_32x32x16_bf16 v[80:95], v[160:163], v[60:63], v[80:95]
    ds_read_b64_tr_b16 v[108:109], v20 offset:45056
    ds_read_b64_tr_b16 v[110:111], v20 offset:45568
    s_waitcnt lgkmcnt(5)
    v_mfma_f32_32x32x16_bf16 v[64:79], v[96:99], v[164:167], v[64:79]
    ds_read_b128 v[172:175], v19 offset:32768
    ds_read_b64_tr_b16 v[112:113], v20 offset:38912
    ds_read_b64_tr_b16 v[114:115], v20 offset:39424
    v_mfma_f32_32x32x16_bf16 v[80:95], v[164:167], v[100:103], v[80:95]
    ds_read_b64_tr_b16 v[116:117], v20 offset:47104
    ds_read_b64_tr_b16 v[118:119], v20 offset:47616
    s_cmp_lg_u32 s73, 7
    s_cbranch_scc1 F_E2
    s_waitcnt vmcnt(4)
    s_mov_b64 exec, 1
    v_and_b32 v124, 31, v124
    v_cmp_eq_u32 vcc, 31, v124
    s_cbranch_vccz F_E2n
    s_memrealtime s[26:27]
    s_waitcnt lgkmcnt(0)
    s_or_b32 s26, s26, 1
    v_mov_b32 v124, s26
    v_mov_b32 v125, s27
    buffer_store_dwordx2 v[124:125], v7, s[56:59], 0 offen sc1
F_E2n:
    s_mov_b64 exec, -1
F_E2:
    s_waitcnt lgkmcnt(5)
    v_mfma_f32_32x32x16_bf16 v[64:79], v[104:107], v[168:171], v[64:79]
    s_waitcnt vmcnt(4) lgkmcnt(0)
    s_barrier
    v_mfma_f32_32x32x16_bf16 v[80:95], v[168:171], v[108:111], v[80:95]
    ds_read_b128 v[176:179], v16 offset:0
    ds_read_b64_tr_b16 v[40:41], v20 offset:0
    ds_read_b64_tr_b16 v[42:43], v20 offset:512
    ds_read_b64_tr_b16 v[44:45], v20 offset:8192
    ds_read_b64_tr_b16 v[46:47], v20 offset:8704
    s_add_u32 s88, s88, 1
    s_cmp_eq_u32 s88, 8
    s_cselect_b32 s3, -6, 1
    s_lshl_b32 s16, s3, 7
    s_mul_i32 s18, s3, 196608
    s_add_u32 m0, s63, 32768
    s_nop 0
    buffer_load_dwordx4 v2, s[28:31], s64 offen lds
    s_add_u32 s64, s64, s16
    s_add_u32 m0, s63, 40960
    s_nop 0
    buffer_load_dwordx4 v2, s[28:31], s65 offen lds
    s_add_u32 s65, s65, s16
    v_mfma_f32_32x32x16_bf16 v[64:79], v[112:115], v[172:175], v[64:79]
    ds_read_b128 v[180:183], v17 offset:0
    ds_read_b64_tr_b16 v[48:49], v20 offset:2048
    ds_read_b64_tr_b16 v[50:51], v20 offset:2560
    v_mfma_f32_32x32x16_bf16 v[80:95], v[172:175], v[116:119], v[80:95]
    ds_read_b64_tr_b16 v[52:53], v20 offset:10240
    ds_read_b64_tr_b16 v[54:55], v20 offset:10752
    s_add_u32 m0, s63, 81920
    s_nop 0
    buffer_load_dwordx4 v3, s[32:35], s66 offen lds
    s_add_u32 s66, s66, s18
    s_add_u32 m0, s63, 90112
    s_nop 0
    buffer_load_dwordx4 v3, s[32:35], s67 offen lds
    s_add_u32 s67, s67, s18
    s_cmp_ge_u32 s60, 2
    s_cbranch_scc1 F_WPHK
    s_lshl_b32 s3, s62, 11
    s_add_u32 s3, s3, s63
    s_add_u32 m0, s63, 155648
    s_nop 0
    buffer_load_dwordx4 v12, s[40:43], s3 offen lds
F_WPHK:
    s_cmp_lg_u32 s60, 2
    s_cbranch_scc1 F_GD
    s_lshl_b32 s3, s76, 7
    v_add_u32 v6, s3, v12
    v_subrev_u32 v5, 896, v6
    v_cmp_le_u32 vcc, 1024, v6
    s_nop 1
    v_cndmask_b32 v6, v6, v5, vcc
    v_cmp_gt_u32 vcc, 8, v0
    s_nop 1
    v_cndmask_b32 v6, v6, v12, vcc
    s_mov_b32 m0, 157696
    s_nop 0
    buffer_load_dwordx4 v6, s[8:11], 0 offen lds
F_GD:
    s_waitcnt lgkmcnt(5)
    v_mfma_f32_32x32x16_bf16 v[64:79], v[40:43], v[176:179], v[64:79]
    ds_read_b128 v[184:187], v18 offset:0
    ds_read_b64_tr_b16 v[56:57], v20 offset:4096
    ds_read_b64_tr_b16 v[58:59], v20 offset:4608
    v_mfma_f32_32x32x16_bf16 v[80:95], v[176:179], v[44:47], v[80:95]
    ds_read_b64_tr_b16 v[60:61], v20 offset:12288
    ds_read_b64_tr_b16 v[62:63], v20 offset:12800
    s_waitcnt lgkmcnt(5)
    v_mfma_f32_32x32x16_bf16 v[64:79], v[48:51], v[180:183], v[64:79]
    ds_read_b128 v[188:191], v19 offset:0
    ds_read_b64_tr_b16 v[96:97], v20 offset:6144
    ds_read_b64_tr_b16 v[98:99], v20 offset:6656
    v_mfma_f32_32x32x16_bf16 v[80:95], v[180:183], v[52:55], v[80:95]
    ds_read_b64_tr_b16 v[100:101], v20 offset:14336
    ds_read_b64_tr_b16 v[102:103], v20 offset:14848
    s_waitcnt lgkmcnt(5)
    v_mfma_f32_32x32x16_bf16 v[64:79], v[56:59], v[184:187], v[64:79]
    s_waitcnt vmcnt(4) lgkmcnt(0)
    s_barrier
    v_mfma_f32_32x32x16_bf16 v[80:95], v[184:187], v[60:63], v[80:95]
    ds_read_b128 v[192:195], v16 offset:16384
    ds_read_b64_tr_b16 v[104:105], v20 offset:16384
    ds_read_b64_tr_b16 v[106:107], v20 offset:16896
    ds_read_b64_tr_b16 v[108:109], v20 offset:24576
    ds_read_b64_tr_b16 v[110:111], v20 offset:25088
    s_add_u32 s88, s88, 1
    s_cmp_eq_u32 s88, 8
    s_cselect_b32 s3, -6, 1
    s_lshl_b32 s16, s3, 7
    s_mul_i32 s18, s3, 196608
    s_add_u32 m0, s63, 0
    s_nop 0
    buffer_load_dwordx4 v2, s[28:31], s64 offen lds
    s_add_u32 s64, s64, s16
    s_add_u32 m0, s63, 8192
    s_nop 0
    buffer_load_dwordx4 v2, s[28:31], s65 offen lds
    s_add_u32 s65, s65, s16
    v_mfma_f32_32x32x16_bf16 v[64:79], v[96:99], v[188:191], v[64:79]
    ds_read_b128 v[196:199], v17 offset:16384
    ds_read_b64_tr_b16 v[112:113], v20 offset:18432
    ds_read_b64_tr_b16 v[114:115], v20 offset:18944
    v_mfma_f32_32x32x16_bf16 v[80:95], v[188:191], v[100:103], v[80:95]
    ds_read_b64_tr_b16 v[116:117], v20 offset:26624
    ds_read_b64_tr_b16 v[118:119], v20 offset:27136
    s_add_u32 m0, s63, 49152
    s_nop 0
    buffer_load_dwordx4 v3, s[32:35], s66 offen lds
    s_add_u32 s66, s66, s18
    s_add_u32 m0, s63, 57344
    s_nop 0
    buffer_load_dwordx4 v3, s[32:35], s67 offen lds
    s_add_u32 s67, s67, s18
    s_waitcnt lgkmcnt(5)
    v_mfma_f32_32x32x16_bf16 v[64:79], v[104:107], v[192:195], v[64:79]
    ds_read_b128 v[200:203], v18 offset:16384
    ds_read_b64_tr_b16 v[40:41], v20 offset:20480
    ds_read_b64_tr_b16 v[42:43], v20 offset:20992
    v_mfma_f32_32x32x16_bf16 v[80:95], v[192:195], v[108:111], v[80:95]
    ds_read_b64_tr_b16 v[44:45], v20 offset:28672
    ds_read_b64_tr_b16 v[46:47], v20 offset:29184
    s_waitcnt lgkmcnt(5)
    v_mfma_f32_32x32x16_bf16 v[64:79], v[112:115], v[196:199], v[64:79]
    ds_read_b128 v[204:207], v19 offset:16384
    ds_read_b64_tr_b16 v[48:49], v20 offset:22528
    ds_read_b64_tr_b16 v[50:51], v20 offset:23040
    v_mfma_f32_32x32x16_bf16 v[80:95], v[196:199], v[116:119], v[80:95]
    ds_read_b64_tr_b16 v[52:53], v20 offset:30720
    ds_read_b64_tr_b16 v[54:55], v20 offset:31232
    s_lshr_b32 s3, s82, 3
    s_mul_i32 s68, s3, 458752
    s_and_b32 s26, s82, 3
    s_mul_i32 s27, s26, 69632
    s_add_u32 s68, s68, s27
    s_lshl_b32 s27, s83, 12
    s_add_u32 s68, s68, s27
    s_add_u32 s68, s68, 180224
    s_lshl_b32 s3, s3, 2
    s_add_u32 s3, s3, s26
    s_lshl_b32 s69, s3, 15
    s_add_u32 s69, s69, s27
    v_lshlrev_b32 v127, 6, v0
    s_waitcnt lgkmcnt(5)
    v_mfma_f32_32x32x16_bf16 v[64:79], v[40:43], v[200:203], v[64:79]
    s_waitcnt vmcnt(4) lgkmcnt(0)
    s_barrier
    v_mfma_f32_32x32x16_bf16 v[80:95], v[200:203], v[44:47], v[80:95]
    ds_read_b128 v[208:211], v16 offset:32768
    ds_read_b64_tr_b16 v[56:57], v20 offset:32768
    ds_read_b64_tr_b16 v[58:59], v20 offset:33280
    ds_read_b64_tr_b16 v[60:61], v20 offset:40960
    ds_read_b64_tr_b16 v[62:63], v20 offset:41472
    s_add_u32 m0, s63, 16384
    s_nop 0
    buffer_load_dwordx4 v2, s[28:31], s64 offen lds
    s_add_u32 m0, s63, 24576
    s_nop 0
    buffer_load_dwordx4 v2, s[28:31], s65 offen lds
    v_mfma_f32_32x32x16_bf16 v[64:79], v[48:51], v[204:207], v[64:79]
    ds_read_b128 v[212:215], v17 offset:32768
    ds_read_b64_tr_b16 v[96:97], v20 offset:34816
    ds_read_b64_tr_b16 v[98:99], v20 offset:35328
    v_mfma_f32_32x32x16_bf16 v[80:95], v[204:207], v[52:55], v[80:95]
    ds_read_b64_tr_b16 v[100:101], v20 offset:43008
    ds_read_b64_tr_b16 v[102:103], v20 offset:43520
    s_add_u32 m0, s63, 65536
    s_nop 0
    buffer_load_dwordx4 v3, s[32:35], s66 offen lds
    s_add_u32 m0, s63, 73728
    s_nop 0
    buffer_load_dwordx4 v3, s[32:35], s67 offen lds
    s_waitcnt lgkmcnt(5)
    v_mfma_f32_32x32x16_bf16 v[64:79], v[56:59], v[208:211], v[64:79]
    ds_read_b128 v[216:219], v18 offset:32768
    ds_read_b64_tr_b16 v[104:105], v20 offset:36864
    ds_read_b64_tr_b16 v[106:107], v20 offset:37376
    v_mfma_f32_32x32x16_bf16 v[80:95], v[208:211], v[60:63], v[80:95]
    ds_read_b64_tr_b16 v[108:109], v20 offset:45056
    ds_read_b64_tr_b16 v[110:111], v20 offset:45568
    s_lshl_b32 s3, s60, 12
    s_add_u32 m0, s3, 98304
    s_add_u32 s3, s70, 0
    buffer_load_dwordx4 v13, s[4:7], s3 offen lds
    s_lshl_b32 s3, s60, 12
    s_add_u32 m0, s3, 99328
    s_add_u32 s3, s70, 57344
    buffer_load_dwordx4 v13, s[4:7], s3 offen lds
    s_waitcnt lgkmcnt(5)
    v_mfma_f32_32x32x16_bf16 v[64:79], v[96:99], v[212:215], v[64:79]
    ds_read_b128 v[220:223], v19 offset:32768
    ds_read_b64_tr_b16 v[112:113], v20 offset:38912
    ds_read_b64_tr_b16 v[114:115], v20 offset:39424
    v_mfma_f32_32x32x16_bf16 v[80:95], v[212:215], v[100:103], v[80:95]
    ds_read_b64_tr_b16 v[116:117], v20 offset:47104
    ds_read_b64_tr_b16 v[118:119], v20 offset:47616
    s_lshl_b32 s3, s60, 12
    s_add_u32 m0, s3, 100352
    s_add_u32 s3, s70, 114688
    buffer_load_dwordx4 v13, s[4:7], s3 offen lds
    s_lshl_b32 s3, s60, 12
    s_add_u32 m0, s3, 101376
    s_add_u32 s3, s70, 172032
    buffer_load_dwordx4 v13, s[4:7], s3 offen lds
    s_lshl_b32 s3, s60, 11
    v_add_u32 v120, s3, v12
    v_bfe_u32 v121, v8, 1, 2
    v_lshlrev_b32 v122, 1, v9
    v_xor_b32 v121, v121, v122
    v_lshlrev_b32 v121, 4, v121
    v_lshl_add_u32 v121, v8, 6, v121
    s_lshl_b32 s3, s84, 14
    s_lshl_b32 s26, s83, 11
    s_add_u32 s3, s3, s26
    s_add_u32 s3, s3, 49152
    v_add_u32 v121, s3, v121
    v_xor_b32 v122, 16, v121
    s_waitcnt lgkmcnt(5)
    v_mfma_f32_32x32x16_bf16 v[64:79], v[104:107], v[216:219], v[64:79]
    s_waitcnt vmcnt(8) lgkmcnt(0)
    s_barrier
    v_mfma_f32_32x32x16_bf16 v[80:95], v[216:219], v[108:111], v[80:95]
    ds_read_b128 v[224:227], v16 offset:0
    ds_read_b64_tr_b16 v[40:41], v20 offset:0
    ds_read_b64_tr_b16 v[42:43], v20 offset:512
    ds_read_b64_tr_b16 v[44:45], v20 offset:8192
    ds_read_b64_tr_b16 v[46:47], v20 offset:8704
    s_lshr_b32 s3, s82, 3
    s_lshl_b32 s3, s3, 2
    s_and_b32 s26, s82, 3
    s_add_u32 s3, s3, s26
    s_lshl_b32 s3, s3, 3
    s_add_u32 s3, s3, s81
    v_lshlrev_b32 v6, 6, v0
    s_lshl_b32 s26, s84, 7
    s_add_u32 s26, s26, s3
    s_lshl_b32 s3, s3, 2
    s_add_u32 s3, s3, s83
    s_lshl_b32 s3, s3, 12
    s_cmp_lt_u32 s26, 112
    s_cselect_b32 s3, s3, 0
    s_cselect_b64 exec, -1, 0
    buffer_load_dword v14, v6, s[44:47], s3 offen
    s_mov_b64 exec, -1
    s_lshr_b32 s3, s82, 3
    s_lshl_b32 s3, s3, 2
    s_and_b32 s26, s82, 3
    s_add_u32 s3, s3, s26
    s_lshl_b32 s3, s3, 3
    s_add_u32 s3, s3, s81
    v_lshlrev_b32 v6, 6, v0
    s_lshl_b32 s3, s3, 12
    s_cmp_eq_u32 s60, 4
    s_cselect_b64 exec, -1, 0
    buffer_load_dword v14, v6, s[48:51], s3 offen
    s_mov_b64 exec, -1
    v_mfma_f32_32x32x16_bf16 v[64:79], v[112:115], v[220:223], v[64:79]
    ds_read_b128 v[228:231], v17 offset:0
    ds_read_b64_tr_b16 v[48:49], v20 offset:2048
    ds_read_b64_tr_b16 v[50:51], v20 offset:2560
    v_mfma_f32_32x32x16_bf16 v[80:95], v[220:223], v[116:119], v[80:95]
    ds_read_b64_tr_b16 v[52:53], v20 offset:10240
    ds_read_b64_tr_b16 v[54:55], v20 offset:10752
    s_waitcnt lgkmcnt(5)
    v_mfma_f32_32x32x16_bf16 v[64:79], v[40:43], v[224:227], v[64:79]
    ds_read_b128 v[232:235], v18 offset:0
    ds_read_b64_tr_b16 v[56:57], v20 offset:4096
    ds_read_b64_tr_b16 v[58:59], v20 offset:4608
    v_mfma_f32_32x32x16_bf16 v[80:95], v[224:227], v[44:47], v[80:95]
    ds_read_b64_tr_b16 v[60:61], v20 offset:12288
    ds_read_b64_tr_b16 v[62:63], v20 offset:12800
    s_waitcnt lgkmcnt(5)
    v_mfma_f32_32x32x16_bf16 v[64:79], v[48:51], v[228:231], v[64:79]
    ds_read_b128 v[236:239], v19 offset:0
    ds_read_b64_tr_b16 v[96:97], v20 offset:6144
    ds_read_b64_tr_b16 v[98:99], v20 offset:6656
    v_mfma_f32_32x32x16_bf16 v[80:95], v[228:231], v[52:55], v[80:95]
    ds_read_b64_tr_b16 v[100:101], v20 offset:14336
    ds_read_b64_tr_b16 v[102:103], v20 offset:14848
    v_and_b32 v4, 1, v0
    v_lshlrev_b32 v4, 1, v4
    v_bfe_u32 v5, v0, 4, 1
    v_add_u32 v4, v4, v5
    v_lshrrev_b32 v6, 1, v10
    v_lshl_add_u32 v6, v9, 1, v6
    v_xor_b32 v4, v4, v6
    v_lshlrev_b32 v4, 4, v4
    v_bfe_u32 v6, v0, 1, 1
    v_lshl_add_u32 v4, v6, 3, v4
    v_lshl_add_u32 v6, v9, 2, v10
    v_lshl_add_u32 v4, v6, 6, v4
    s_lshl_b32 s3, s83, 13
    s_add_u32 s3, s3, 49152
    v_add_u32 v123, s3, v4
    s_lshr_b32 s3, s83, 1
    s_lshl_b32 s3, s3, 13
    v_add_u32 v124, s3, v12
    v_cmp_eq_u32 s[88:89], s87, v5
    v_and_b32 v4, 15, v0
    v_lshlrev_b32 v6, 2, v4
    v_lshl_add_u32 v125, v9, 6, v6
    v_bfe_u32 v4, v0, 3, 2
    v_lshlrev_b32 v4, 5, v4
    v_and_b32 v6, 3, v0
    v_lshl_add_u32 v4, v6, 3, v4
    v_and_b32 v6, 4, v0
    v_add_u32 v126, v4, v6
    s_waitcnt lgkmcnt(5)
    v_mfma_f32_32x32x16_bf16 v[64:79], v[56:59], v[232:235], v[64:79]
    s_waitcnt vmcnt(6) lgkmcnt(0)
    s_barrier
    v_mfma_f32_32x32x16_bf16 v[80:95], v[232:235], v[60:63], v[80:95]
    ds_read_b128 v[240:243], v16 offset:16384
    ds_read_b64_tr_b16 v[104:105], v20 offset:16384
    ds_read_b64_tr_b16 v[106:107], v20 offset:16896
    ds_read_b64_tr_b16 v[108:109], v20 offset:24576
    ds_read_b64_tr_b16 v[110:111], v20 offset:25088
    v_mfma_f32_32x32x16_bf16 v[64:79], v[96:99], v[236:239], v[64:79]
    ds_read_b128 v[244:247], v17 offset:16384
    ds_read_b64_tr_b16 v[112:113], v20 offset:18432
    ds_read_b64_tr_b16 v[114:115], v20 offset:18944
    v_mfma_f32_32x32x16_bf16 v[80:95], v[236:239], v[100:103], v[80:95]
    ds_read_b64_tr_b16 v[116:117], v20 offset:26624
    ds_read_b64_tr_b16 v[118:119], v20 offset:27136
    v_lshl_add_u32 v4, v9, 2, v10
    v_lshlrev_b32 v4, 5, v4
    v_bfe_u32 v5, v0, 4, 1
    v_lshl_add_u32 v4, v5, 4, v4
    v_bfe_u32 v5, v0, 1, 1
    v_lshl_add_u32 v6, v5, 3, v4
    s_lshl_b32 s3, s84, 10
    s_add_u32 s3, s3, 155648
    v_add_u32 v6, s3, v6
    ds_read_b64_tr_b16 v[24:25], v6 offset:0
    ds_read_b64_tr_b16 v[26:27], v6 offset:256
    ds_read_b64_tr_b16 v[28:29], v6 offset:512
    ds_read_b64_tr_b16 v[30:31], v6 offset:768
    v_bfe_u32 v127, v0, 2, 1
    v_mul_u32_u24 v127, 0x8000, v127
    v_lshl_or_b32 v127, v127, 16, v127
    s_waitcnt lgkmcnt(5)
    v_mfma_f32_32x32x16_bf16 v[64:79], v[104:107], v[240:243], v[64:79]
    ds_read_b128 v[248:251], v18 offset:16384
    ds_read_b64_tr_b16 v[40:41], v20 offset:20480
    ds_read_b64_tr_b16 v[42:43], v20 offset:20992
    v_mfma_f32_32x32x16_bf16 v[80:95], v[240:243], v[108:111], v[80:95]
    ds_read_b64_tr_b16 v[44:45], v20 offset:28672
    ds_read_b64_tr_b16 v[46:47], v20 offset:29184
    s_waitcnt lgkmcnt(5)
    v_mfma_f32_32x32x16_bf16 v[64:79], v[112:115], v[244:247], v[64:79]
    ds_read_b128 v[252:255], v19 offset:16384
    ds_read_b64_tr_b16 v[48:49], v20 offset:22528
    ds_read_b64_tr_b16 v[50:51], v20 offset:23040
    v_mfma_f32_32x32x16_bf16 v[80:95], v[244:247], v[116:119], v[80:95]
    ds_read_b64_tr_b16 v[52:53], v20 offset:30720
    ds_read_b64_tr_b16 v[54:55], v20 offset:31232
    s_add_u32 m0, s24, 147456
    s_add_u32 s20, s23, 0
    buffer_load_dwordx4 v15, s[44:47], s20 offen lds
    s_add_u32 m0, s24, 131072
    s_add_u32 s20, s23, 81920
    buffer_load_dwordx4 v15, s[44:47], s20 offen lds
    s_waitcnt lgkmcnt(0)
    v_xor_b32 v24, v24, v127
    v_xor_b32 v25, v25, v127
    v_xor_b32 v26, v26, v127
    v_xor_b32 v27, v27, v127
    v_xor_b32 v28, v28, v127
    v_xor_b32 v29, v29, v127
    v_xor_b32 v30, v30, v127
    v_xor_b32 v31, v31, v127
    s_waitcnt lgkmcnt(5)
    v_mfma_f32_32x32x16_bf16 v[64:79], v[40:43], v[248:251], v[64:79]
    s_add_u32 m0, s24, 139264
    s_add_u32 s20, s23, 98304
    buffer_load_dwordx4 v15, s[44:47], s20 offen lds
    v_mfma_f32_32x32x16_bf16 v[80:95], v[248:251], v[44:47], v[80:95]
    s_waitcnt lgkmcnt(0)
    v_mfma_f32_32x32x16_bf16 v[64:79], v[48:51], v[252:255], v[64:79]
    v_mfma_f32_32x32x16_bf16 v[80:95], v[252:255], v[52:55], v[80:95]
    buffer_load_dwordx2 v[22:23], v7, s[56:59], 0 offen sc1
    s_nop 9
    v_cvt_pk_bf16_f32 v96, v64, v65
    v_cvt_pk_bf16_f32 v97, v66, v67
    v_cvt_pk_bf16_f32 v98, v68, v69
    v_cvt_pk_bf16_f32 v99, v70, v71
    v_cvt_pk_bf16_f32 v100, v72, v73
    v_cvt_pk_bf16_f32 v101, v74, v75
    v_cvt_pk_bf16_f32 v102, v76, v77
    v_cvt_pk_bf16_f32 v103, v78, v79
    v_mfma_f32_32x32x16_bf16 v[40:55], v[24:27], v[96:99], 0
    s_nop 0
    v_mfma_f32_32x32x16_bf16 v[64:79], v[28:31], v[100:103], 0
    v_cvt_pk_bf16_f32 v80, v80, v81
    v_cvt_pk_bf16_f32 v81, v82, v83
    v_cvt_pk_bf16_f32 v82, v84, v85
    v_cvt_pk_bf16_f32 v83, v86, v87
    v_cvt_pk_bf16_f32 v84, v88, v89
    v_cvt_pk_bf16_f32 v85, v90, v91
    v_cvt_pk_bf16_f32 v86, v92, v93
    v_cvt_pk_bf16_f32 v87, v94, v95
    s_barrier
    ds_write_b128 v120, v[80:83] offset:0
    ds_write_b128 v120, v[84:87] offset:1024
    s_cmp_lt_u32 s60, 4
    s_cbranch_scc1 F_KS1
    s_lshr_b32 s3, s82, 3
    s_lshl_b32 s3, s3, 2
    s_and_b32 s26, s82, 3
    s_add_u32 s3, s3, s26
    s_lshl_b32 s26, s83, 4
    s_add_u32 s3, s3, s26
    v_lshrrev_b32 v6, 1, v0
    v_lshlrev_b32 v6, 10, v6
    v_and_b32 v5, 1, v0
    v_lshl_add_u32 v6, v5, 6, v6
    s_cmp_lt_u32 s3, 56
    s_cselect_b32 s3, s3, 0
    s_cselect_b64 exec, -1, 0
    s_lshl_b32 s3, s3, 15
    buffer_load_dword v14, v6, s[44:47], s3 offen offset:384
    s_mov_b64 exec, -1
    s_lshr_b32 s3, s82, 3
    s_lshl_b32 s3, s3, 2
    s_and_b32 s26, s82, 3
    s_add_u32 s3, s3, s26
    s_lshl_b32 s26, s83, 4
    s_add_u32 s3, s3, s26
    v_lshrrev_b32 v6, 1, v0
    v_lshlrev_b32 v6, 10, v6
    v_and_b32 v5, 1, v0
    v_lshl_add_u32 v6, v5, 6, v6
    s_sub_u32 s3, s3, 48
    s_cmp_lt_u32 s3, 16
    s_cselect_b32 s3, s3, 0
    s_cselect_b64 exec, -1, 0
    s_lshl_b32 s3, s3, 15
    buffer_load_dword v14, v6, s[48:51], s3 offen offset:384
    s_mov_b64 exec, -1
    s_add_u32 m0, s24, 31744
    s_add_u32 s20, s23, 8192
    buffer_load_dwordx4 v15, s[44:47], s20 offen lds
    s_add_u32 m0, s24, 32768
    s_add_u32 s20, s23, 16384
    buffer_load_dwordx4 v15, s[44:47], s20 offen lds
    s_add_u32 m0, s24, 39936
    s_add_u32 s20, s23, 24576
    buffer_load_dwordx4 v15, s[44:47], s20 offen lds
    s_add_u32 m0, s24, 40960
    s_add_u32 s20, s23, 32768
    buffer_load_dwordx4 v15, s[44:47], s20 offen lds
F_KS1:
    v_max3_f32 v4, v40, v41, v42
    v_max3_f32 v88, v64, v65, v66
    v_max3_f32 v5, v43, v44, v45
    v_max3_f32 v89, v67, v68, v69
    v_max3_f32 v4, v4, v46, v47
    v_max3_f32 v88, v88, v70, v71
    v_max3_f32 v5, v5, v48, v49
    v_max3_f32 v89, v89, v72, v73
    v_max3_f32 v4, v4, v50, v51
    v_max3_f32 v88, v88, v74, v75
    v_max3_f32 v5, v5, v52, v53
    v_max3_f32 v89, v89, v76, v77
    v_max3_f32 v4, v4, v54, v55
    v_max3_f32 v88, v88, v78, v79
    v_max_f32 v4, v4, v5
    v_max_f32 v88, v88, v89
    v_mul_f32 v4, s74, v4
    v_mul_f32 v88, s74, v88
    v_pk_fma_f32 v[40:41], v[40:41], s[74:75], v[4:5] op_sel_hi:[1,1,0] neg_lo:[0,0,1] neg_hi:[0,0,1]
    v_pk_fma_f32 v[64:65], v[64:65], s[74:75], v[88:89] op_sel_hi:[1,1,0] neg_lo:[0,0,1] neg_hi:[0,0,1]
    v_pk_fma_f32 v[42:43], v[42:43], s[74:75], v[4:5] op_sel_hi:[1,1,0] neg_lo:[0,0,1] neg_hi:[0,0,1]
    v_pk_fma_f32 v[66:67], v[66:67], s[74:75], v[88:89] op_sel_hi:[1,1,0] neg_lo:[0,0,1] neg_hi:[0,0,1]
    v_pk_fma_f32 v[44:45], v[44:45], s[74:75], v[4:5] op_sel_hi:[1,1,0] neg_lo:[0,0,1] neg_hi:[0,0,1]
    v_pk_fma_f32 v[68:69], v[68:69], s[74:75], v[88:89] op_sel_hi:[1,1,0] neg_lo:[0,0,1] neg_hi:[0,0,1]
    v_pk_fma_f32 v[46:47], v[46:47], s[74:75], v[4:5] op_sel_hi:[1,1,0] neg_lo:[0,0,1] neg_hi:[0,0,1]
    v_pk_fma_f32 v[70:71], v[70:71], s[74:75], v[88:89] op_sel_hi:[1,1,0] neg_lo:[0,0,1] neg_hi:[0,0,1]
    v_pk_fma_f32 v[48:49], v[48:49], s[74:75], v[4:5] op_sel_hi:[1,1,0] neg_lo:[0,0,1] neg_hi:[0,0,1]
    v_pk_fma_f32 v[72:73], v[72:73], s[74:75], v[88:89] op_sel_hi:[1,1,0] neg_lo:[0,0,1] neg_hi:[0,0,1]
    v_pk_fma_f32 v[50:51], v[50:51], s[74:75], v[4:5] op_sel_hi:[1,1,0] neg_lo:[0,0,1] neg_hi:[0,0,1]
    v_pk_fma_f32 v[74:75], v[74:75], s[74:75], v[88:89] op_sel_hi:[1,1,0] neg_lo:[0,0,1] neg_hi:[0,0,1]
    v_pk_fma_f32 v[52:53], v[52:53], s[74:75], v[4:5] op_sel_hi:[1,1,0] neg_lo:[0,0,1] neg_hi:[0,0,1]
    v_pk_fma_f32 v[76:77], v[76:77], s[74:75], v[88:89] op_sel_hi:[1,1,0] neg_lo:[0,0,1] neg_hi:[0,0,1]
    v_pk_fma_f32 v[54:55], v[54:55], s[74:75], v[4:5] op_sel_hi:[1,1,0] neg_lo:[0,0,1] neg_hi:[0,0,1]
    v_pk_fma_f32 v[78:79], v[78:79], s[74:75], v[88:89] op_sel_hi:[1,1,0] neg_lo:[0,0,1] neg_hi:[0,0,1]
    v_exp_f32 v40, v40
    v_exp_f32 v64, v64
    v_exp_f32 v41, v41
    v_exp_f32 v65, v65
    v_exp_f32 v42, v42
    v_exp_f32 v66, v66
    v_exp_f32 v43, v43
    v_exp_f32 v67, v67
    v_exp_f32 v44, v44
    v_exp_f32 v68, v68
    v_exp_f32 v45, v45
    v_exp_f32 v69, v69
    v_exp_f32 v46, v46
    v_exp_f32 v70, v70
    v_exp_f32 v47, v47
    v_exp_f32 v71, v71
    v_exp_f32 v48, v48
    v_exp_f32 v72, v72
    v_exp_f32 v49, v49
    v_exp_f32 v73, v73
    v_exp_f32 v50, v50
    v_exp_f32 v74, v74
    v_exp_f32 v51, v51
    v_exp_f32 v75, v75
    v_exp_f32 v52, v52
    v_exp_f32 v76, v76
    v_exp_f32 v53, v53
    v_exp_f32 v77, v77
    v_exp_f32 v54, v54
    v_exp_f32 v78, v78
    v_exp_f32 v55, v55
    v_exp_f32 v79, v79
    v_pk_add_f32 v[4:5], v[40:41], v[42:43]
    v_pk_add_f32 v[88:89], v[64:65], v[66:67]
    v_pk_add_f32 v[4:5], v[4:5], v[44:45]
    v_pk_add_f32 v[88:89], v[88:89], v[68:69]
    v_pk_add_f32 v[4:5], v[4:5], v[46:47]
    v_pk_add_f32 v[88:89], v[88:89], v[70:71]
    v_pk_add_f32 v[4:5], v[4:5], v[48:49]
    v_pk_add_f32 v[88:89], v[88:89], v[72:73]
    v_pk_add_f32 v[4:5], v[4:5], v[50:51]
    v_pk_add_f32 v[88:89], v[88:89], v[74:75]
    v_pk_add_f32 v[4:5], v[4:5], v[52:53]
    v_pk_add_f32 v[88:89], v[88:89], v[76:77]
    v_pk_add_f32 v[4:5], v[4:5], v[54:55]
    v_pk_add_f32 v[88:89], v[88:89], v[78:79]
    v_add_f32 v4, v4, v5
    v_add_f32 v88, v88, v89
    v_rcp_f32 v4, v4
    v_rcp_f32 v88, v88
    v_pk_mul_f32 v[40:41], v[40:41], v[4:5] op_sel_hi:[1,0]
    v_pk_mul_f32 v[64:65], v[64:65], v[88:89] op_sel_hi:[1,0]
    v_pk_mul_f32 v[42:43], v[42:43], v[4:5] op_sel_hi:[1,0]
    v_pk_mul_f32 v[66:67], v[66:67], v[88:89] op_sel_hi:[1,0]
    v_pk_mul_f32 v[44:45], v[44:45], v[4:5] op_sel_hi:[1,0]
    v_pk_mul_f32 v[68:69], v[68:69], v[88:89] op_sel_hi:[1,0]
    v_pk_mul_f32 v[46:47], v[46:47], v[4:5] op_sel_hi:[1,0]
    v_pk_mul_f32 v[70:71], v[70:71], v[88:89] op_sel_hi:[1,0]
    v_pk_mul_f32 v[48:49], v[48:49], v[4:5] op_sel_hi:[1,0]
    v_pk_mul_f32 v[72:73], v[72:73], v[88:89] op_sel_hi:[1,0]
    v_pk_mul_f32 v[50:51], v[50:51], v[4:5] op_sel_hi:[1,0]
    v_pk_mul_f32 v[74:75], v[74:75], v[88:89] op_sel_hi:[1,0]
    v_pk_mul_f32 v[52:53], v[52:53], v[4:5] op_sel_hi:[1,0]
    v_pk_mul_f32 v[76:77], v[76:77], v[88:89] op_sel_hi:[1,0]
    v_pk_mul_f32 v[54:55], v[54:55], v[4:5] op_sel_hi:[1,0]
    v_pk_mul_f32 v[78:79], v[78:79], v[88:89] op_sel_hi:[1,0]
    v_cvt_pk_bf16_f32 v40, v40, v41
    v_cvt_pk_bf16_f32 v64, v64, v65
    v_cvt_pk_bf16_f32 v41, v42, v43
    v_cvt_pk_bf16_f32 v65, v66, v67
    v_cvt_pk_bf16_f32 v42, v44, v45
    v_cvt_pk_bf16_f32 v66, v68, v69
    v_cvt_pk_bf16_f32 v43, v46, v47
    v_cvt_pk_bf16_f32 v67, v70, v71
    v_cvt_pk_bf16_f32 v44, v48, v49
    v_cvt_pk_bf16_f32 v68, v72, v73
    v_cvt_pk_bf16_f32 v45, v50, v51
    v_cvt_pk_bf16_f32 v69, v74, v75
    v_cvt_pk_bf16_f32 v46, v52, v53
    v_cvt_pk_bf16_f32 v70, v76, v77
    v_cvt_pk_bf16_f32 v47, v54, v55
    v_cvt_pk_bf16_f32 v71, v78, v79
    ds_write_b128 v121, v[40:43] offset:0
    ds_write_b128 v122, v[44:47] offset:0
    ds_write_b128 v121, v[64:67] offset:8192
    ds_write_b128 v122, v[68:71] offset:8192
    v_mov_b32 v92, 0x3f803f80
    v_mov_b32 v93, 0x3f803f80
    v_mov_b32 v94, 0x3f803f80
    v_mov_b32 v95, 0x3f803f80
    s_waitcnt vmcnt(6) lgkmcnt(0)
    s_cmp_ge_u32 s60, 4
    s_cbranch_scc1 F_KS2
    s_waitcnt vmcnt(0)
F_KS2:
    s_mov_b32 s87, 0
F_EK_S:
    v_cmp_eq_u32 vcc, 0, v22
    s_cbranch_vccz F_EK_G
    s_add_u32 s87, s87, 1
    s_cmp_ge_u32 s87, 0x20000
    s_cbranch_scc1 F_EK_G
    buffer_load_dwordx2 v[22:23], v7, s[56:59], 0 offen sc1
    s_waitcnt vmcnt(0)
    s_sleep 2
    s_branch F_EK_S
F_EK_G:
    s_barrier
    s_cmp_ge_u32 s60, 4
    s_cbranch_scc1 F_KB
    ds_read_b64_tr_b16 v[40:41], v123 offset:0
    ds_read_b64_tr_b16 v[42:43], v123 offset:512
    ds_read_b128 v[44:47], v124 offset:0
    ds_read_b64_tr_b16 v[48:49], v123 offset:1024
    ds_read_b64_tr_b16 v[50:51], v123 offset:1536
    ds_read_b128 v[52:55], v124 offset:1024
    ds_read_b64_tr_b16 v[56:57], v123 offset:2048
    ds_read_b64_tr_b16 v[58:59], v123 offset:2560
    ds_read_b128 v[60:63], v124 offset:2048
    ds_read_b64_tr_b16 v[24:25], v123 offset:3072
    ds_read_b64_tr_b16 v[26:27], v123 offset:3584
    ds_read_b128 v[28:31], v124 offset:3072
    ds_read_b64_tr_b16 v[32:33], v123 offset:4096
    ds_read_b64_tr_b16 v[34:35], v123 offset:4608
    ds_read_b128 v[36:39], v124 offset:4096
    s_waitcnt lgkmcnt(12)
    v_mfma_f32_32x32x16_bf16 v[64:79], v[40:43], v[44:47], 0
    v_mfma_f32_32x32x16_bf16 v[96:111], v[92:95], v[40:43], 0
    ds_read_b64_tr_b16 v[40:41], v123 offset:5120
    ds_read_b64_tr_b16 v[42:43], v123 offset:5632
    ds_read_b128 v[44:47], v124 offset:5120
    s_waitcnt lgkmcnt(12)
    v_mfma_f32_32x32x16_bf16 v[64:79], v[48:51], v[52:55], v[64:79]
    v_mfma_f32_32x32x16_bf16 v[96:111], v[92:95], v[48:51], v[96:111]
    ds_read_b64_tr_b16 v[48:49], v123 offset:6144
    ds_read_b64_tr_b16 v[50:51], v123 offset:6656
    ds_read_b128 v[52:55], v124 offset:6144
    s_waitcnt lgkmcnt(12)
    v_mfma_f32_32x32x16_bf16 v[64:79], v[56:59], v[60:63], v[64:79]
    v_mfma_f32_32x32x16_bf16 v[96:111], v[92:95], v[56:59], v[96:111]
    ds_read_b64_tr_b16 v[56:57], v123 offset:7168
    ds_read_b64_tr_b16 v[58:59], v123 offset:7680
    ds_read_b128 v[60:63], v124 offset:7168
    s_waitcnt lgkmcnt(12)
    v_mfma_f32_32x32x16_bf16 v[64:79], v[24:27], v[28:31], v[64:79]
    v_mfma_f32_32x32x16_bf16 v[96:111], v[92:95], v[24:27], v[96:111]
    s_waitcnt lgkmcnt(9)
    v_mfma_f32_32x32x16_bf16 v[64:79], v[32:35], v[36:39], v[64:79]
    v_mfma_f32_32x32x16_bf16 v[96:111], v[92:95], v[32:35], v[96:111]
    s_waitcnt lgkmcnt(6)
    v_mfma_f32_32x32x16_bf16 v[64:79], v[40:43], v[44:47], v[64:79]
    v_mfma_f32_32x32x16_bf16 v[96:111], v[92:95], v[40:43], v[96:111]
    s_waitcnt lgkmcnt(3)
    v_mfma_f32_32x32x16_bf16 v[64:79], v[48:51], v[52:55], v[64:79]
    v_mfma_f32_32x32x16_bf16 v[96:111], v[92:95], v[48:51], v[96:111]
    s_waitcnt lgkmcnt(0)
    v_mfma_f32_32x32x16_bf16 v[64:79], v[56:59], v[60:63], v[64:79]
    v_mfma_f32_32x32x16_bf16 v[96:111], v[92:95], v[56:59], v[96:111]
    s_mov_b64 exec, 1
    v_mov_b32 v4, 158720
    v_mov_b32 v5, 1
    ds_add_u32 v4, v5 offset:12
    s_mov_b64 exec, s[88:89]
    s_nop 5
    buffer_atomic_add_f32 v64, v125, s[36:39], s71 offen offset:0
    buffer_atomic_add_f32 v65, v125, s[36:39], s71 offen offset:128
    buffer_atomic_add_f32 v66, v125, s[36:39], s71 offen offset:256
    buffer_atomic_add_f32 v67, v125, s[36:39], s71 offen offset:384
    buffer_atomic_add_f32 v68, v125, s[36:39], s71 offen offset:512
    buffer_atomic_add_f32 v69, v125, s[36:39], s71 offen offset:640
    buffer_atomic_add_f32 v70, v125, s[36:39], s71 offen offset:768
    buffer_atomic_add_f32 v71, v125, s[36:39], s71 offen offset:896
    buffer_atomic_add_f32 v72, v125, s[36:39], s71 offen offset:1024
    buffer_atomic_add_f32 v73, v125, s[36:39], s71 offen offset:1152
    buffer_atomic_add_f32 v74, v125, s[36:39], s71 offen offset:1280
    buffer_atomic_add_f32 v75, v125, s[36:39], s71 offen offset:1408
    buffer_atomic_add_f32 v76, v125, s[36:39], s71 offen offset:1536
    buffer_atomic_add_f32 v77, v125, s[36:39], s71 offen offset:1664
    buffer_atomic_add_f32 v78, v125, s[36:39], s71 offen offset:1792
    buffer_atomic_add_f32 v79, v125, s[36:39], s71 offen offset:1920
    s_mov_b32 exec_lo, -1
    s_mov_b32 exec_hi, 0
    buffer_atomic_add_f32 v96, v126, s[36:39], s71 offen offset:2048
    s_mov_b64 exec, -1
    s_add_u32 m0, s24, 16384
    s_add_u32 s20, s23, 212992
    buffer_load_dwordx4 v15, s[44:47], s20 offen lds
    s_add_u32 m0, s24, 17408
    s_add_u32 s20, s23, 221184
    buffer_load_dwordx4 v15, s[44:47], s20 offen lds
    s_add_u32 m0, s24, 24576
    s_add_u32 s20, s23, 229376
    buffer_load_dwordx4 v15, s[44:47], s20 offen lds
    s_add_u32 m0, s24, 25600
    s_add_u32 s20, s23, 237568
    buffer_load_dwordx4 v15, s[44:47], s20 offen lds
    s_add_u32 m0, s24, 81920
    s_add_u32 s20, s23, 245760
    buffer_load_dwordx4 v15, s[44:47], s20 offen lds
    s_add_u32 m0, s24, 82944
    s_add_u32 s20, s23, 253952
    buffer_load_dwordx4 v15, s[44:47], s20 offen lds
    s_add_u32 m0, s24, 90112
    s_add_u32 s20, s23, 262144
    buffer_load_dwordx4 v15, s[44:47], s20 offen lds
    s_add_u32 m0, s24, 91136
    s_add_u32 s20, s23, 270336
    buffer_load_dwordx4 v15, s[44:47], s20 offen lds
    v_lshl_add_u32 v4, v9, 2, v10
    v_lshlrev_b32 v4, 7, v4
    s_and_b32 s3, s83, 1
    s_lshl_b32 s3, s3, 5
    v_xor_b32 v5, s3, v11
    v_add_u32 v4, v4, v5
    s_lshl_b32 s3, s83, 11
    v_add_u32 v4, s3, v4
    s_lshr_b32 s3, s83, 1
    v_lshrrev_b32 v5, 1, v10
    v_xor_b32 v5, s3, v5
    v_lshl_add_u32 v16, v5, 6, v4
    v_xor_b32 v17, 64, v16
    v_add_u32 v18, 65536, v16
    v_add_u32 v20, 131072, v16
    v_add_u32 v19, 65536, v17
    v_add_u32 v21, 131072, v17
    v_and_b32 v3, 15, v0
    v_lshlrev_b32 v3, 7, v3
    s_cmp_lg_u32 s100, 0
    s_cselect_b32 s3, 2, 0
    v_and_b32 v4, s3, v0
    v_lshlrev_b32 v4, 9, v4
    v_and_b32 v5, 1, v0
    v_lshlrev_b32 v5, 7, v5
    s_lshl_b32 s3, s83, 8
    v_add_u32 v10, s3, v5
    v_add_u32 v11, v4, v10
    v_lshlrev_b32 v1, 2, v8
    s_lshr_b32 s27, s79, 1
    s_lshl_b32 s70, s27, 11
    s_add_u32 s70, s70, 14761984
    s_lshl_b32 s27, s27, 10
    s_lshl_b32 s3, s83, 8
    s_add_u32 s27, s27, s3
    s_add_u32 s19, s27, 14794752
    s_add_u32 s3, s70, 1024
    s_sub_u32 s26, s19, s3
    s_mov_b32 s19, s3
    v_lshlrev_b32 v4, 7, v0
    v_add_u32 v4, s26, v4
    v_cmp_gt_u32 vcc, 2, v0
    s_nop 1
    v_cndmask_b32 v13, v7, v4, vcc
    v_lshrrev_b32 v4, 1, v0
    v_cmp_eq_u32 vcc, 1, v4
    s_nop 1
    v_cndmask_b32 v13, v13, v10, vcc
    s_mul_i32 s85, s79, 295040
    s_lshl_b32 s3, s84, 10
    s_add_u32 s85, s85, s3
    s_lshl_b32 s3, s83, 14
    s_add_u32 s86, s85, s3
    s_add_u32 s86, s86, 229376
    s_mul_i32 s3, s83, 57344
    s_add_u32 s85, s85, s3
    s_mul_i32 s3, s100, 14336
    s_add_u32 s85, s85, s3
    s_lshl_b32 s3, s79, 8
    s_lshl_b32 s26, s84, 7
    s_add_u32 s3, s3, s26
    s_add_u32 s21, s3, 14680064
    v_mov_b32 v5, 158720
    s_mov_b32 s87, 0
F_KW_S:
    ds_read_b32 v4, v5 offset:12
    s_waitcnt lgkmcnt(0)
    v_cmp_gt_u32 vcc, 4, v4
    s_cbranch_vccz F_KW_G
    s_add_u32 s87, s87, 1
    s_cmp_ge_u32 s87, 0x400000
    s_cbranch_scc0 F_KW_S
F_KW_G:
    s_add_u32 m0, s24, 0
    s_add_u32 s20, s23, 114688
    buffer_load_dwordx4 v15, s[44:47], s20 offen lds
    s_add_u32 m0, s24, 1024
    s_add_u32 s20, s23, 122880
    buffer_load_dwordx4 v15, s[44:47], s20 offen lds
    s_waitcnt vmcnt(10)
    s_mov_b64 exec, 1
    v_mov_b32 v4, 158720
    v_mov_b32 v5, 1
    ds_add_rtn_u32 v6, v4, v5 offset:0
    s_waitcnt lgkmcnt(0)
    v_cmp_eq_u32 vcc, 3, v6
    s_cbranch_vccz F_KF
    buffer_store_dwordx2 v[22:23], v7, s[36:39], s22 offen sc1
F_KF:
    s_mov_b64 exec, -1
    s_add_u32 m0, s24, 8192
    s_add_u32 s20, s23, 131072
    buffer_load_dwordx4 v15, s[44:47], s20 offen lds
    s_add_u32 m0, s24, 9216
    s_add_u32 s20, s23, 139264
    buffer_load_dwordx4 v15, s[44:47], s20 offen lds
    s_add_u32 m0, s24, 49152
    s_add_u32 s20, s23, 147456
    buffer_load_dwordx4 v15, s[44:47], s20 offen lds
    s_add_u32 m0, s24, 50176
    s_add_u32 s20, s23, 155648
    buffer_load_dwordx4 v15, s[44:47], s20 offen lds
    s_add_u32 m0, s24, 57344
    s_add_u32 s20, s23, 163840
    buffer_load_dwordx4 v15, s[44:47], s20 offen lds
    s_add_u32 m0, s24, 58368
    s_add_u32 s20, s23, 172032
    buffer_load_dwordx4 v15, s[44:47], s20 offen lds
    s_add_u32 m0, s24, 65536
    s_add_u32 s20, s23, 180224
    buffer_load_dwordx4 v15, s[44:47], s20 offen lds
    s_add_u32 m0, s24, 66560
    s_add_u32 s20, s23, 188416
    buffer_load_dwordx4 v15, s[44:47], s20 offen lds
    s_add_u32 m0, s24, 73728
    s_add_u32 s20, s23, 196608
    buffer_load_dwordx4 v15, s[44:47], s20 offen lds
    s_add_u32 m0, s24, 74752
    s_add_u32 s20, s23, 204800
    buffer_load_dwordx4 v15, s[44:47], s20 offen lds
    s_waitcnt vmcnt(12)
    s_barrier
    ds_read_b64_tr_b16 v[112:113], v20 offset:16384
    ds_read_b64_tr_b16 v[114:115], v20 offset:17408
    ds_read_b64_tr_b16 v[116:117], v21 offset:16384
    ds_read_b64_tr_b16 v[118:119], v21 offset:17408
    ds_read_b64_tr_b16 v[152:153], v20 offset:0
    ds_read_b64_tr_b16 v[154:155], v20 offset:1024
    ds_read_b64_tr_b16 v[156:157], v21 offset:0
    ds_read_b64_tr_b16 v[158:159], v21 offset:1024
    ds_read_b64_tr_b16 v[160:161], v20 offset:8192
    ds_read_b64_tr_b16 v[162:163], v20 offset:9216
    ds_read_b64_tr_b16 v[164:165], v21 offset:8192
    ds_read_b64_tr_b16 v[166:167], v21 offset:9216
    ds_read_b64_tr_b16 v[120:121], v16 offset:32768
    ds_read_b64_tr_b16 v[122:123], v16 offset:33792
    ds_read_b64_tr_b16 v[124:125], v17 offset:32768
    ds_read_b64_tr_b16 v[126:127], v17 offset:33792
    ds_read_b64_tr_b16 v[128:129], v16 offset:40960
    ds_read_b64_tr_b16 v[130:131], v16 offset:41984
    ds_read_b64_tr_b16 v[132:133], v17 offset:40960
    ds_read_b64_tr_b16 v[134:135], v17 offset:41984
    ds_read_b64_tr_b16 v[216:217], v16 offset:16384
    ds_read_b64_tr_b16 v[218:219], v16 offset:17408
    ds_read_b64_tr_b16 v[220:221], v17 offset:16384
    ds_read_b64_tr_b16 v[222:223], v17 offset:17408
    ds_read_b64_tr_b16 v[224:225], v16 offset:24576
    ds_read_b64_tr_b16 v[226:227], v16 offset:25600
    ds_read_b64_tr_b16 v[228:229], v17 offset:24576
    ds_read_b64_tr_b16 v[230:231], v17 offset:25600
    ds_read_b64_tr_b16 v[232:233], v18 offset:16384
    ds_read_b64_tr_b16 v[234:235], v18 offset:17408
    ds_read_b64_tr_b16 v[236:237], v19 offset:16384
    ds_read_b64_tr_b16 v[238:239], v19 offset:17408
    ds_read_b64_tr_b16 v[240:241], v18 offset:24576
    ds_read_b64_tr_b16 v[242:243], v18 offset:25600
    ds_read_b64_tr_b16 v[244:245], v19 offset:24576
    ds_read_b64_tr_b16 v[246:247], v19 offset:25600
    s_add_u32 m0, s24, 114688
    s_add_u32 s20, s23, 49152
    buffer_load_dwordx4 v15, s[44:47], s20 offen lds
    s_add_u32 m0, s24, 115712
    s_add_u32 s20, s23, 57344
    buffer_load_dwordx4 v15, s[44:47], s20 offen lds
    s_add_u32 m0, s24, 122880
    s_add_u32 s20, s23, 65536
    buffer_load_dwordx4 v15, s[44:47], s20 offen lds
    s_add_u32 m0, s24, 123904
    s_add_u32 s20, s23, 73728
    buffer_load_dwordx4 v15, s[44:47], s20 offen lds
    s_add_u32 m0, s24, 98304
    s_add_u32 s20, s23, 278528
    buffer_load_dwordx4 v15, s[44:47], s20 offen lds
    s_add_u32 m0, s24, 99328
    s_add_u32 s20, s23, 286720
    buffer_load_dwordx4 v15, s[44:47], s20 offen lds
    s_waitcnt vmcnt(6) lgkmcnt(0)
    s_barrier
    s_add_u32 m0, s24, 147456
    s_add_u32 s20, s23, 294912
    buffer_load_dwordx4 v15, s[44:47], s20 offen lds
    s_add_u32 m0, s24, 148480
    s_add_u32 s20, s23, 303104
    buffer_load_dwordx4 v15, s[44:47], s20 offen lds
    s_add_u32 m0, s24, 32768
    s_add_u32 s20, s23, 311296
    buffer_load_dwordx4 v15, s[44:47], s20 offen lds
    s_add_u32 m0, s24, 33792
    s_add_u32 s20, s23, 319488
    buffer_load_dwordx4 v15, s[44:47], s20 offen lds
    s_add_u32 m0, s24, 40960
    s_add_u32 s20, s23, 327680
    buffer_load_dwordx4 v15, s[44:47], s20 offen lds
    s_add_u32 m0, s24, 41984
    s_add_u32 s20, s23, 335872
    buffer_load_dwordx4 v15, s[44:47], s20 offen lds
    ds_read_b64_tr_b16 v[168:169], v16 offset:0
    ds_read_b64_tr_b16 v[170:171], v16 offset:1024
    ds_read_b64_tr_b16 v[172:173], v17 offset:0
    ds_read_b64_tr_b16 v[174:175], v17 offset:1024
    ds_read_b64_tr_b16 v[176:177], v16 offset:8192
    ds_read_b64_tr_b16 v[178:179], v16 offset:9216
    ds_read_b64_tr_b16 v[180:181], v17 offset:8192
    ds_read_b64_tr_b16 v[182:183], v17 offset:9216
    ds_read_b64_tr_b16 v[184:185], v16 offset:49152
    ds_read_b64_tr_b16 v[186:187], v16 offset:50176
    ds_read_b64_tr_b16 v[188:189], v17 offset:49152
    ds_read_b64_tr_b16 v[190:191], v17 offset:50176
    ds_read_b64_tr_b16 v[192:193], v16 offset:57344
    ds_read_b64_tr_b16 v[194:195], v16 offset:58368
    ds_read_b64_tr_b16 v[196:197], v17 offset:57344
    ds_read_b64_tr_b16 v[198:199], v17 offset:58368
    ds_read_b64_tr_b16 v[200:201], v18 offset:0
    ds_read_b64_tr_b16 v[202:203], v18 offset:1024
    ds_read_b64_tr_b16 v[204:205], v19 offset:0
    ds_read_b64_tr_b16 v[206:207], v19 offset:1024
    ds_read_b64_tr_b16 v[208:209], v18 offset:8192
    ds_read_b64_tr_b16 v[210:211], v18 offset:9216
    ds_read_b64_tr_b16 v[212:213], v19 offset:8192
    ds_read_b64_tr_b16 v[214:215], v19 offset:9216
    s_add_u32 m0, s24, 131072
    s_add_u32 s20, s23, 376832
    buffer_load_dwordx4 v15, s[44:47], s20 offen lds
    s_add_u32 m0, s24, 132096
    s_add_u32 s20, s23, 385024
    buffer_load_dwordx4 v15, s[44:47], s20 offen lds
    s_add_u32 m0, s24, 139264
    s_add_u32 s20, s23, 393216
    buffer_load_dwordx4 v15, s[44:47], s20 offen lds
    s_add_u32 m0, s24, 140288
    s_add_u32 s20, s23, 401408
    buffer_load_dwordx4 v15, s[44:47], s20 offen lds
    s_waitcnt vmcnt(10)
    s_barrier
    ds_read_b64_tr_b16 v[136:137], v18 offset:49152
    ds_read_b64_tr_b16 v[138:139], v18 offset:50176
    ds_read_b64_tr_b16 v[140:141], v19 offset:49152
    ds_read_b64_tr_b16 v[142:143], v19 offset:50176
    ds_read_b64_tr_b16 v[144:145], v18 offset:57344
    ds_read_b64_tr_b16 v[146:147], v18 offset:58368
    ds_read_b64_tr_b16 v[148:149], v19 offset:57344
    ds_read_b64_tr_b16 v[150:151], v19 offset:58368
    ds_read_b64_tr_b16 v[248:249], v18 offset:32768
    ds_read_b64_tr_b16 v[250:251], v18 offset:33792
    ds_read_b64_tr_b16 v[252:253], v19 offset:32768
    ds_read_b64_tr_b16 v[254:255], v19 offset:33792
    s_add_u32 m0, s24, 16384
    s_add_u32 s20, s25, 49152
    buffer_load_dwordx4 v15, s[48:51], s20 offen lds
    s_add_u32 m0, s24, 17408
    s_add_u32 s20, s25, 57344
    buffer_load_dwordx4 v15, s[48:51], s20 offen lds
    s_add_u32 m0, s24, 24576
    s_add_u32 s20, s25, 65536
    buffer_load_dwordx4 v15, s[48:51], s20 offen lds
    s_add_u32 m0, s24, 25600
    s_add_u32 s20, s25, 73728
    buffer_load_dwordx4 v15, s[48:51], s20 offen lds
    s_add_u32 m0, s24, 81920
    s_add_u32 s20, s25, 81920
    buffer_load_dwordx4 v15, s[48:51], s20 offen lds
    s_add_u32 m0, s24, 82944
    s_add_u32 s20, s25, 90112
    buffer_load_dwordx4 v15, s[48:51], s20 offen lds
    s_add_u32 m0, s24, 90112
    s_add_u32 s20, s25, 98304
    buffer_load_dwordx4 v15, s[48:51], s20 offen lds
    s_add_u32 m0, s24, 91136
    s_add_u32 s20, s25, 106496
    buffer_load_dwordx4 v15, s[48:51], s20 offen lds
    s_waitcnt lgkmcnt(0)
    s_barrier
    s_add_u32 m0, s24, 114688
    s_add_u32 s20, s23, 344064
    buffer_load_dwordx4 v15, s[44:47], s20 offen lds
    s_add_u32 m0, s24, 115712
    s_add_u32 s20, s23, 352256
    buffer_load_dwordx4 v15, s[44:47], s20 offen lds
    s_add_u32 m0, s24, 122880
    s_add_u32 s20, s23, 360448
    buffer_load_dwordx4 v15, s[44:47], s20 offen lds
    s_add_u32 m0, s24, 123904
    s_add_u32 s20, s23, 368640
    buffer_load_dwordx4 v15, s[44:47], s20 offen lds
    s_add_u32 m0, s24, 0
    s_add_u32 s20, s23, 409600
    buffer_load_dwordx4 v15, s[44:47], s20 offen lds
    s_add_u32 m0, s24, 1024
    s_add_u32 s20, s23, 417792
    buffer_load_dwordx4 v15, s[44:47], s20 offen lds
    s_add_u32 m0, s24, 8192
    s_add_u32 s20, s23, 425984
    buffer_load_dwordx4 v15, s[44:47], s20 offen lds
    s_add_u32 m0, s24, 9216
    s_add_u32 s20, s23, 434176
    buffer_load_dwordx4 v15, s[44:47], s20 offen lds
    s_add_u32 m0, s24, 49152
    s_add_u32 s20, s23, 442368
    buffer_load_dwordx4 v15, s[44:47], s20 offen lds
    s_add_u32 m0, s24, 50176
    s_add_u32 s20, s23, 450560
    buffer_load_dwordx4 v15, s[44:47], s20 offen lds
    s_add_u32 m0, s24, 57344
    s_add_u32 s20, s25, 0
    buffer_load_dwordx4 v15, s[48:51], s20 offen lds
    s_add_u32 m0, s24, 58368
    s_add_u32 s20, s25, 8192
    buffer_load_dwordx4 v15, s[48:51], s20 offen lds
    s_add_u32 m0, s24, 65536
    s_add_u32 s20, s25, 16384
    buffer_load_dwordx4 v15, s[48:51], s20 offen lds
    s_add_u32 m0, s24, 66560
    s_add_u32 s20, s25, 24576
    buffer_load_dwordx4 v15, s[48:51], s20 offen lds
    buffer_load_dwordx2 v[38:39], v11, s[36:39], s70 offen sc1
    s_add_u32 m0, s24, 73728
    s_add_u32 s20, s25, 32768
    buffer_load_dwordx4 v15, s[48:51], s20 offen lds
    s_add_u32 m0, s24, 74752
    s_add_u32 s20, s25, 40960
    buffer_load_dwordx4 v15, s[48:51], s20 offen lds
    s_add_u32 m0, s24, 98304
    s_add_u32 s20, s25, 114688
    buffer_load_dwordx4 v15, s[48:51], s20 offen lds
    s_add_u32 m0, s24, 99328
    s_add_u32 s20, s25, 122880
    buffer_load_dwordx4 v15, s[48:51], s20 offen lds
    s_mov_b32 s88, 2
    s_waitcnt vmcnt(4)
    s_branch F_MAIN
F_KB:
    s_cmp_eq_u32 s62, 0
    s_cbranch_scc1 F_KG
    ds_read_b64_tr_b16 v[40:41], v21 offset:0
    ds_read_b64_tr_b16 v[42:43], v21 offset:256
    ds_read_b64_tr_b16 v[44:45], v21 offset:1024
    ds_read_b64_tr_b16 v[46:47], v21 offset:1280
    ds_read_b64_tr_b16 v[48:49], v21 offset:2048
    ds_read_b64_tr_b16 v[50:51], v21 offset:2304
    ds_read_b64_tr_b16 v[52:53], v21 offset:3072
    ds_read_b64_tr_b16 v[54:55], v21 offset:3328
    s_waitcnt lgkmcnt(6)
    v_mfma_f32_32x32x16_bf16 v[96:111], v[40:43], v[128:131], 0
    ds_read_b64_tr_b16 v[56:57], v21 offset:4096
    ds_read_b64_tr_b16 v[58:59], v21 offset:4352
    s_waitcnt lgkmcnt(6)
    v_mfma_f32_32x32x16_bf16 v[96:111], v[44:47], v[132:135], v[96:111]
    ds_read_b64_tr_b16 v[60:61], v21 offset:5120
    ds_read_b64_tr_b16 v[62:63], v21 offset:5376
    s_waitcnt lgkmcnt(6)
    v_mfma_f32_32x32x16_bf16 v[96:111], v[48:51], v[136:139], v[96:111]
    ds_read_b64_tr_b16 v[40:41], v21 offset:6144
    ds_read_b64_tr_b16 v[42:43], v21 offset:6400
    s_waitcnt lgkmcnt(6)
    v_mfma_f32_32x32x16_bf16 v[96:111], v[52:55], v[140:143], v[96:111]
    ds_read_b64_tr_b16 v[44:45], v21 offset:7168
    ds_read_b64_tr_b16 v[46:47], v21 offset:7424
    s_waitcnt lgkmcnt(6)
    v_mfma_f32_32x32x16_bf16 v[96:111], v[56:59], v[144:147], v[96:111]
    ds_read_b64_tr_b16 v[48:49], v21 offset:8192
    ds_read_b64_tr_b16 v[50:51], v21 offset:8448
    s_waitcnt lgkmcnt(6)
    v_mfma_f32_32x32x16_bf16 v[96:111], v[60:63], v[148:151], v[96:111]
    ds_read_b64_tr_b16 v[52:53], v21 offset:9216
    ds_read_b64_tr_b16 v[54:55], v21 offset:9472
    s_waitcnt lgkmcnt(6)
    v_mfma_f32_32x32x16_bf16 v[96:111], v[40:43], v[152:155], v[96:111]
    ds_read_b64_tr_b16 v[56:57], v21 offset:10240
    ds_read_b64_tr_b16 v[58:59], v21 offset:10496
    s_waitcnt lgkmcnt(6)
    v_mfma_f32_32x32x16_bf16 v[96:111], v[44:47], v[156:159], v[96:111]
    ds_read_b64_tr_b16 v[60:61], v21 offset:11264
    ds_read_b64_tr_b16 v[62:63], v21 offset:11520
    s_waitcnt lgkmcnt(6)
    v_mfma_f32_32x32x16_bf16 v[96:111], v[48:51], v[160:163], v[96:111]
    ds_read_b64_tr_b16 v[40:41], v21 offset:12288
    ds_read_b64_tr_b16 v[42:43], v21 offset:12544
    s_waitcnt lgkmcnt(6)
    v_mfma_f32_32x32x16_bf16 v[96:111], v[52:55], v[164:167], v[96:111]
    ds_read_b64_tr_b16 v[44:45], v21 offset:13312
    ds_read_b64_tr_b16 v[46:47], v21 offset:13568
    s_waitcnt lgkmcnt(6)
    v_mfma_f32_32x32x16_bf16 v[96:111], v[56:59], v[168:171], v[96:111]
    ds_read_b64_tr_b16 v[48:49], v21 offset:14336
    ds_read_b64_tr_b16 v[50:51], v21 offset:14592
    s_waitcnt lgkmcnt(6)
    v_mfma_f32_32x32x16_bf16 v[96:111], v[60:63], v[172:175], v[96:111]
    ds_read_b64_tr_b16 v[52:53], v21 offset:15360
    ds_read_b64_tr_b16 v[54:55], v21 offset:15616
    s_waitcnt lgkmcnt(6)
    v_mfma_f32_32x32x16_bf16 v[96:111], v[40:43], v[176:179], v[96:111]
    ds_read_b64_tr_b16 v[56:57], v21 offset:16384
    ds_read_b64_tr_b16 v[58:59], v21 offset:16640
    s_waitcnt lgkmcnt(6)
    v_mfma_f32_32x32x16_bf16 v[96:111], v[44:47], v[180:183], v[96:111]
    ds_read_b64_tr_b16 v[60:61], v21 offset:17408
    ds_read_b64_tr_b16 v[62:63], v21 offset:17664
    s_waitcnt lgkmcnt(6)
    v_mfma_f32_32x32x16_bf16 v[96:111], v[48:51], v[184:187], v[96:111]
    ds_read_b64_tr_b16 v[40:41], v21 offset:18432
    ds_read_b64_tr_b16 v[42:43], v21 offset:18688
    s_waitcnt lgkmcnt(6)
    v_mfma_f32_32x32x16_bf16 v[96:111], v[52:55], v[188:191], v[96:111]
    ds_read_b64_tr_b16 v[44:45], v21 offset:19456
    ds_read_b64_tr_b16 v[46:47], v21 offset:19712
    s_waitcnt lgkmcnt(6)
    v_mfma_f32_32x32x16_bf16 v[96:111], v[56:59], v[192:195], v[96:111]
    ds_read_b64_tr_b16 v[48:49], v21 offset:20480
    ds_read_b64_tr_b16 v[50:51], v21 offset:20736
    s_waitcnt lgkmcnt(6)
    v_mfma_f32_32x32x16_bf16 v[96:111], v[60:63], v[196:199], v[96:111]
    ds_read_b64_tr_b16 v[52:53], v21 offset:21504
    ds_read_b64_tr_b16 v[54:55], v21 offset:21760
    s_waitcnt lgkmcnt(6)
    v_mfma_f32_32x32x16_bf16 v[96:111], v[40:43], v[200:203], v[96:111]
    ds_read_b64_tr_b16 v[56:57], v21 offset:22528
    ds_read_b64_tr_b16 v[58:59], v21 offset:22784
    s_waitcnt lgkmcnt(6)
    v_mfma_f32_32x32x16_bf16 v[96:111], v[44:47], v[204:207], v[96:111]
    ds_read_b64_tr_b16 v[60:61], v21 offset:23552
    ds_read_b64_tr_b16 v[62:63], v21 offset:23808
    s_waitcnt lgkmcnt(6)
    v_mfma_f32_32x32x16_bf16 v[96:111], v[48:51], v[208:211], v[96:111]
    ds_read_b64_tr_b16 v[40:41], v21 offset:24576
    ds_read_b64_tr_b16 v[42:43], v21 offset:24832
    s_waitcnt lgkmcnt(6)
    v_mfma_f32_32x32x16_bf16 v[96:111], v[52:55], v[212:215], v[96:111]
    ds_read_b64_tr_b16 v[44:45], v21 offset:25600
    ds_read_b64_tr_b16 v[46:47], v21 offset:25856
    s_waitcnt lgkmcnt(6)
    v_mfma_f32_32x32x16_bf16 v[96:111], v[56:59], v[216:219], v[96:111]
    ds_read_b64_tr_b16 v[48:49], v21 offset:26624
    ds_read_b64_tr_b16 v[50:51], v21 offset:26880
    s_waitcnt lgkmcnt(6)
    v_mfma_f32_32x32x16_bf16 v[96:111], v[60:63], v[220:223], v[96:111]
    ds_read_b64_tr_b16 v[52:53], v21 offset:27648
    ds_read_b64_tr_b16 v[54:55], v21 offset:27904
    s_waitcnt lgkmcnt(6)
    v_mfma_f32_32x32x16_bf16 v[96:111], v[40:43], v[224:227], v[96:111]
    ds_read_b64_tr_b16 v[56:57], v21 offset:28672
    ds_read_b64_tr_b16 v[58:59], v21 offset:28928
    s_waitcnt lgkmcnt(6)
    v_mfma_f32_32x32x16_bf16 v[96:111], v[44:47], v[228:231], v[96:111]
    ds_read_b64_tr_b16 v[60:61], v21 offset:29696
    ds_read_b64_tr_b16 v[62:63], v21 offset:29952
    s_waitcnt lgkmcnt(6)
    v_mfma_f32_32x32x16_bf16 v[96:111], v[48:51], v[232:235], v[96:111]
    ds_read_b64_tr_b16 v[40:41], v21 offset:30720
    ds_read_b64_tr_b16 v[42:43], v21 offset:30976
    s_waitcnt lgkmcnt(6)
    v_mfma_f32_32x32x16_bf16 v[96:111], v[52:55], v[236:239], v[96:111]
    ds_read_b64_tr_b16 v[44:45], v21 offset:31744
    ds_read_b64_tr_b16 v[46:47], v21 offset:32000
    s_waitcnt lgkmcnt(6)
    v_mfma_f32_32x32x16_bf16 v[96:111], v[56:59], v[240:243], v[96:111]
    s_waitcnt lgkmcnt(4)
    v_mfma_f32_32x32x16_bf16 v[96:111], v[60:63], v[244:247], v[96:111]
    s_waitcnt lgkmcnt(2)
    v_mfma_f32_32x32x16_bf16 v[96:111], v[40:43], v[248:251], v[96:111]
    s_waitcnt lgkmcnt(0)
    v_mfma_f32_32x32x16_bf16 v[96:111], v[44:47], v[252:255], v[96:111]
    s_branch F_KG2
F_KG:
    v_lshlrev_b32 v20, 4, v9
    v_add_u32 v20, 157696, v20
    ds_read_b64_tr_b16 v[40:41], v21 offset:0
    ds_read_b64_tr_b16 v[42:43], v21 offset:256
    ds_read_b128 v[64:67], v20 offset:0
    ds_read_b64_tr_b16 v[44:45], v21 offset:1024
    ds_read_b64_tr_b16 v[46:47], v21 offset:1280
    ds_read_b128 v[68:71], v20 offset:32
    ds_read_b64_tr_b16 v[48:49], v21 offset:2048
    ds_read_b64_tr_b16 v[50:51], v21 offset:2304
    ds_read_b128 v[72:75], v20 offset:64
    ds_read_b64_tr_b16 v[52:53], v21 offset:3072
    ds_read_b64_tr_b16 v[54:55], v21 offset:3328
    ds_read_b128 v[76:79], v20 offset:96
    s_waitcnt lgkmcnt(9)
    v_mfma_f32_32x32x16_bf16 v[96:111], v[40:43], v[128:131], 0
    v_mfma_f32_32x32x16_bf16 v[112:127], v[64:67], v[128:131], 0
    ds_read_b64_tr_b16 v[56:57], v21 offset:4096
    ds_read_b64_tr_b16 v[58:59], v21 offset:4352
    ds_read_b128 v[80:83], v20 offset:128
    s_waitcnt lgkmcnt(9)
    v_mfma_f32_32x32x16_bf16 v[96:111], v[44:47], v[132:135], v[96:111]
    v_mfma_f32_32x32x16_bf16 v[112:127], v[68:71], v[132:135], v[112:127]
    ds_read_b64_tr_b16 v[60:61], v21 offset:5120
    ds_read_b64_tr_b16 v[62:63], v21 offset:5376
    ds_read_b128 v[84:87], v20 offset:160
    s_waitcnt lgkmcnt(9)
    v_mfma_f32_32x32x16_bf16 v[96:111], v[48:51], v[136:139], v[96:111]
    v_mfma_f32_32x32x16_bf16 v[112:127], v[72:75], v[136:139], v[112:127]
    ds_read_b64_tr_b16 v[40:41], v21 offset:6144
    ds_read_b64_tr_b16 v[42:43], v21 offset:6400
    ds_read_b128 v[64:67], v20 offset:192
    s_waitcnt lgkmcnt(9)
    v_mfma_f32_32x32x16_bf16 v[96:111], v[52:55], v[140:143], v[96:111]
    v_mfma_f32_32x32x16_bf16 v[112:127], v[76:79], v[140:143], v[112:127]
    ds_read_b64_tr_b16 v[44:45], v21 offset:7168
    ds_read_b64_tr_b16 v[46:47], v21 offset:7424
    ds_read_b128 v[68:71], v20 offset:224
    s_waitcnt lgkmcnt(9)
    v_mfma_f32_32x32x16_bf16 v[96:111], v[56:59], v[144:147], v[96:111]
    v_mfma_f32_32x32x16_bf16 v[112:127], v[80:83], v[144:147], v[112:127]
    ds_read_b64_tr_b16 v[48:49], v21 offset:8192
    ds_read_b64_tr_b16 v[50:51], v21 offset:8448
    ds_read_b128 v[72:75], v20 offset:256
    s_waitcnt lgkmcnt(9)
    v_mfma_f32_32x32x16_bf16 v[96:111], v[60:63], v[148:151], v[96:111]
    v_mfma_f32_32x32x16_bf16 v[112:127], v[84:87], v[148:151], v[112:127]
    ds_read_b64_tr_b16 v[52:53], v21 offset:9216
    ds_read_b64_tr_b16 v[54:55], v21 offset:9472
    ds_read_b128 v[76:79], v20 offset:288
    s_waitcnt lgkmcnt(9)
    v_mfma_f32_32x32x16_bf16 v[96:111], v[40:43], v[152:155], v[96:111]
    v_mfma_f32_32x32x16_bf16 v[112:127], v[64:67], v[152:155], v[112:127]
    ds_read_b64_tr_b16 v[56:57], v21 offset:10240
    ds_read_b64_tr_b16 v[58:59], v21 offset:10496
    ds_read_b128 v[80:83], v20 offset:320
    s_waitcnt lgkmcnt(9)
    v_mfma_f32_32x32x16_bf16 v[96:111], v[44:47], v[156:159], v[96:111]
    v_mfma_f32_32x32x16_bf16 v[112:127], v[68:71], v[156:159], v[112:127]
    ds_read_b64_tr_b16 v[60:61], v21 offset:11264
    ds_read_b64_tr_b16 v[62:63], v21 offset:11520
    ds_read_b128 v[84:87], v20 offset:352
    s_waitcnt lgkmcnt(9)
    v_mfma_f32_32x32x16_bf16 v[96:111], v[48:51], v[160:163], v[96:111]
    v_mfma_f32_32x32x16_bf16 v[112:127], v[72:75], v[160:163], v[112:127]
    ds_read_b64_tr_b16 v[40:41], v21 offset:12288
    ds_read_b64_tr_b16 v[42:43], v21 offset:12544
    ds_read_b128 v[64:67], v20 offset:384
    s_waitcnt lgkmcnt(9)
    v_mfma_f32_32x32x16_bf16 v[96:111], v[52:55], v[164:167], v[96:111]
    v_mfma_f32_32x32x16_bf16 v[112:127], v[76:79], v[164:167], v[112:127]
    ds_read_b64_tr_b16 v[44:45], v21 offset:13312
    ds_read_b64_tr_b16 v[46:47], v21 offset:13568
    ds_read_b128 v[68:71], v20 offset:416
    s_waitcnt lgkmcnt(9)
    v_mfma_f32_32x32x16_bf16 v[96:111], v[56:59], v[168:171], v[96:111]
    v_mfma_f32_32x32x16_bf16 v[112:127], v[80:83], v[168:171], v[112:127]
    ds_read_b64_tr_b16 v[48:49], v21 offset:14336
    ds_read_b64_tr_b16 v[50:51], v21 offset:14592
    ds_read_b128 v[72:75], v20 offset:448
    s_waitcnt lgkmcnt(9)
    v_mfma_f32_32x32x16_bf16 v[96:111], v[60:63], v[172:175], v[96:111]
    v_mfma_f32_32x32x16_bf16 v[112:127], v[84:87], v[172:175], v[112:127]
    ds_read_b64_tr_b16 v[52:53], v21 offset:15360
    ds_read_b64_tr_b16 v[54:55], v21 offset:15616
    ds_read_b128 v[76:79], v20 offset:480
    s_waitcnt lgkmcnt(9)
    v_mfma_f32_32x32x16_bf16 v[96:111], v[40:43], v[176:179], v[96:111]
    v_mfma_f32_32x32x16_bf16 v[112:127], v[64:67], v[176:179], v[112:127]
    ds_read_b64_tr_b16 v[56:57], v21 offset:16384
    ds_read_b64_tr_b16 v[58:59], v21 offset:16640
    ds_read_b128 v[80:83], v20 offset:512
    s_waitcnt lgkmcnt(9)
    v_mfma_f32_32x32x16_bf16 v[96:111], v[44:47], v[180:183], v[96:111]
    v_mfma_f32_32x32x16_bf16 v[112:127], v[68:71], v[180:183], v[112:127]
    ds_read_b64_tr_b16 v[60:61], v21 offset:17408
    ds_read_b64_tr_b16 v[62:63], v21 offset:17664
    ds_read_b128 v[84:87], v20 offset:544
    s_waitcnt lgkmcnt(9)
    v_mfma_f32_32x32x16_bf16 v[96:111], v[48:51], v[184:187], v[96:111]
    v_mfma_f32_32x32x16_bf16 v[112:127], v[72:75], v[184:187], v[112:127]
    ds_read_b64_tr_b16 v[40:41], v21 offset:18432
    ds_read_b64_tr_b16 v[42:43], v21 offset:18688
    ds_read_b128 v[64:67], v20 offset:576
    s_waitcnt lgkmcnt(9)
    v_mfma_f32_32x32x16_bf16 v[96:111], v[52:55], v[188:191], v[96:111]
    v_mfma_f32_32x32x16_bf16 v[112:127], v[76:79], v[188:191], v[112:127]
    ds_read_b64_tr_b16 v[44:45], v21 offset:19456
    ds_read_b64_tr_b16 v[46:47], v21 offset:19712
    ds_read_b128 v[68:71], v20 offset:608
    s_waitcnt lgkmcnt(9)
    v_mfma_f32_32x32x16_bf16 v[96:111], v[56:59], v[192:195], v[96:111]
    v_mfma_f32_32x32x16_bf16 v[112:127], v[80:83], v[192:195], v[112:127]
    ds_read_b64_tr_b16 v[48:49], v21 offset:20480
    ds_read_b64_tr_b16 v[50:51], v21 offset:20736
    ds_read_b128 v[72:75], v20 offset:640
    s_waitcnt lgkmcnt(9)
    v_mfma_f32_32x32x16_bf16 v[96:111], v[60:63], v[196:199], v[96:111]
    v_mfma_f32_32x32x16_bf16 v[112:127], v[84:87], v[196:199], v[112:127]
    ds_read_b64_tr_b16 v[52:53], v21 offset:21504
    ds_read_b64_tr_b16 v[54:55], v21 offset:21760
    ds_read_b128 v[76:79], v20 offset:672
    s_waitcnt lgkmcnt(9)
    v_mfma_f32_32x32x16_bf16 v[96:111], v[40:43], v[200:203], v[96:111]
    v_mfma_f32_32x32x16_bf16 v[112:127], v[64:67], v[200:203], v[112:127]
    ds_read_b64_tr_b16 v[56:57], v21 offset:22528
    ds_read_b64_tr_b16 v[58:59], v21 offset:22784
    ds_read_b128 v[80:83], v20 offset:704
    s_waitcnt lgkmcnt(9)
    v_mfma_f32_32x32x16_bf16 v[96:111], v[44:47], v[204:207], v[96:111]
    v_mfma_f32_32x32x16_bf16 v[112:127], v[68:71], v[204:207], v[112:127]
    ds_read_b64_tr_b16 v[60:61], v21 offset:23552
    ds_read_b64_tr_b16 v[62:63], v21 offset:23808
    ds_read_b128 v[84:87], v20 offset:736
    s_waitcnt lgkmcnt(9)
    v_mfma_f32_32x32x16_bf16 v[96:111], v[48:51], v[208:211], v[96:111]
    v_mfma_f32_32x32x16_bf16 v[112:127], v[72:75], v[208:211], v[112:127]
    ds_read_b64_tr_b16 v[40:41], v21 offset:24576
    ds_read_b64_tr_b16 v[42:43], v21 offset:24832
    ds_read_b128 v[64:67], v20 offset:768
    s_waitcnt lgkmcnt(9)
    v_mfma_f32_32x32x16_bf16 v[96:111], v[52:55], v[212:215], v[96:111]
    v_mfma_f32_32x32x16_bf16 v[112:127], v[76:79], v[212:215], v[112:127]
    ds_read_b64_tr_b16 v[44:45], v21 offset:25600
    ds_read_b64_tr_b16 v[46:47], v21 offset:25856
    ds_read_b128 v[68:71], v20 offset:800
    s_waitcnt lgkmcnt(9)
    v_mfma_f32_32x32x16_bf16 v[96:111], v[56:59], v[216:219], v[96:111]
    v_mfma_f32_32x32x16_bf16 v[112:127], v[80:83], v[216:219], v[112:127]
    ds_read_b64_tr_b16 v[48:49], v21 offset:26624
    ds_read_b64_tr_b16 v[50:51], v21 offset:26880
    ds_read_b128 v[72:75], v20 offset:832
    s_waitcnt lgkmcnt(9)
    v_mfma_f32_32x32x16_bf16 v[96:111], v[60:63], v[220:223], v[96:111]
    v_mfma_f32_32x32x16_bf16 v[112:127], v[84:87], v[220:223], v[112:127]
    ds_read_b64_tr_b16 v[52:53], v21 offset:27648
    ds_read_b64_tr_b16 v[54:55], v21 offset:27904
    ds_read_b128 v[76:79], v20 offset:864
    s_waitcnt lgkmcnt(9)
    v_mfma_f32_32x32x16_bf16 v[96:111], v[40:43], v[224:227], v[96:111]
    v_mfma_f32_32x32x16_bf16 v[112:127], v[64:67], v[224:227], v[112:127]
    ds_read_b64_tr_b16 v[56:57], v21 offset:28672
    ds_read_b64_tr_b16 v[58:59], v21 offset:28928
    ds_read_b128 v[80:83], v20 offset:896
    s_waitcnt lgkmcnt(9)
    v_mfma_f32_32x32x16_bf16 v[96:111], v[44:47], v[228:231], v[96:111]
    v_mfma_f32_32x32x16_bf16 v[112:127], v[68:71], v[228:231], v[112:127]
    ds_read_b64_tr_b16 v[60:61], v21 offset:29696
    ds_read_b64_tr_b16 v[62:63], v21 offset:29952
    ds_read_b128 v[84:87], v20 offset:928
    s_waitcnt lgkmcnt(9)
    v_mfma_f32_32x32x16_bf16 v[96:111], v[48:51], v[232:235], v[96:111]
    v_mfma_f32_32x32x16_bf16 v[112:127], v[72:75], v[232:235], v[112:127]
    ds_read_b64_tr_b16 v[40:41], v21 offset:30720
    ds_read_b64_tr_b16 v[42:43], v21 offset:30976
    ds_read_b128 v[64:67], v20 offset:960
    s_waitcnt lgkmcnt(9)
    v_mfma_f32_32x32x16_bf16 v[96:111], v[52:55], v[236:239], v[96:111]
    v_mfma_f32_32x32x16_bf16 v[112:127], v[76:79], v[236:239], v[112:127]
    ds_read_b64_tr_b16 v[44:45], v21 offset:31744
    ds_read_b64_tr_b16 v[46:47], v21 offset:32000
    ds_read_b128 v[68:71], v20 offset:992
    s_waitcnt lgkmcnt(9)
    v_mfma_f32_32x32x16_bf16 v[96:111], v[56:59], v[240:243], v[96:111]
    v_mfma_f32_32x32x16_bf16 v[112:127], v[80:83], v[240:243], v[112:127]
    s_waitcnt lgkmcnt(6)
    v_mfma_f32_32x32x16_bf16 v[96:111], v[60:63], v[244:247], v[96:111]
    v_mfma_f32_32x32x16_bf16 v[112:127], v[84:87], v[244:247], v[112:127]
    s_waitcnt lgkmcnt(3)
    v_mfma_f32_32x32x16_bf16 v[96:111], v[40:43], v[248:251], v[96:111]
    v_mfma_f32_32x32x16_bf16 v[112:127], v[64:67], v[248:251], v[112:127]
    s_waitcnt lgkmcnt(0)
    v_mfma_f32_32x32x16_bf16 v[96:111], v[44:47], v[252:255], v[96:111]
    v_mfma_f32_32x32x16_bf16 v[112:127], v[68:71], v[252:255], v[112:127]
    s_nop 11
    v_mul_f32 v4, s74, v112
    v_exp_f32 v4, -v4
    s_nop 0
    v_add_f32 v4, 1.0, v4
    v_rcp_f32 v4, v4
    v_lshlrev_b32 v5, 2, v8
    s_lshl_b32 s3, s61, 9
    s_lshl_b32 s26, s83, 7
    s_add_u32 s3, s3, s26
    s_add_u32 s3, s3, 14680064
    s_mov_b32 exec_hi, 0
    buffer_store_dword v4, v5, s[36:39], s3 offen sc1
    s_mov_b64 exec, -1
F_KG2:
    s_nop 7
    s_nop 3
    s_waitcnt vmcnt(1)
    v_cvt_pk_bf16_f32 v32, v96, v97
    v_cvt_pk_bf16_f32 v33, v98, v99
    v_cvt_pk_bf16_f32 v34, v100, v101
    v_cvt_pk_bf16_f32 v35, v102, v103
    v_cvt_pk_bf16_f32 v36, v104, v105
    v_cvt_pk_bf16_f32 v37, v106, v107
    v_cvt_pk_bf16_f32 v38, v108, v109
    v_cvt_pk_bf16_f32 v39, v110, v111
    v_pk_max_i16 v32, v32, 0
    v_pk_max_i16 v33, v33, 0
    v_pk_max_i16 v34, v34, 0
    v_pk_max_i16 v35, v35, 0
    v_pk_max_i16 v36, v36, 0
    v_pk_max_i16 v37, v37, 0
    v_pk_max_i16 v38, v38, 0
    v_pk_max_i16 v39, v39, 0
    buffer_store_dwordx4 v[32:35], v12, s[36:39], s72 offen offset:0 sc1
    buffer_store_dwordx4 v[36:39], v12, s[36:39], s72 offen offset:2048 sc1
    v_lshl_add_u32 v4, v9, 2, v10
    v_lshlrev_b32 v4, 7, v4
    s_and_b32 s3, s83, 1
    s_lshl_b32 s3, s3, 5
    v_xor_b32 v5, s3, v11
    v_add_u32 v4, v4, v5
    s_lshl_b32 s3, s83, 11
    v_add_u32 v4, s3, v4
    s_lshr_b32 s3, s83, 1
    v_lshrrev_b32 v5, 1, v10
    v_xor_b32 v5, s3, v5
    v_lshl_add_u32 v16, v5, 6, v4
    v_xor_b32 v17, 64, v16
    v_add_u32 v18, 65536, v16
    v_add_u32 v20, 131072, v16
    v_add_u32 v19, 65536, v17
    v_add_u32 v21, 131072, v17
    v_and_b32 v3, 15, v0
    v_lshlrev_b32 v3, 7, v3
    s_cmp_lg_u32 s100, 0
    s_cselect_b32 s3, 2, 0
    v_and_b32 v4, s3, v0
    v_lshlrev_b32 v4, 9, v4
    v_and_b32 v5, 1, v0
    v_lshlrev_b32 v5, 7, v5
    s_lshl_b32 s3, s83, 8
    v_add_u32 v10, s3, v5
    v_add_u32 v11, v4, v10
    v_lshlrev_b32 v1, 2, v8
    s_lshr_b32 s27, s79, 1
    s_lshl_b32 s70, s27, 11
    s_add_u32 s70, s70, 14761984
    s_lshl_b32 s27, s27, 10
    s_lshl_b32 s3, s83, 8
    s_add_u32 s27, s27, s3
    s_add_u32 s19, s27, 14794752
    s_add_u32 s3, s70, 1024
    s_sub_u32 s26, s19, s3
    s_mov_b32 s19, s3
    v_lshlrev_b32 v4, 7, v0
    v_add_u32 v4, s26, v4
    v_cmp_gt_u32 vcc, 2, v0
    s_nop 1
    v_cndmask_b32 v13, v7, v4, vcc
    v_lshrrev_b32 v4, 1, v0
    v_cmp_eq_u32 vcc, 1, v4
    s_nop 1
    v_cndmask_b32 v13, v13, v10, vcc
    s_mul_i32 s85, s79, 295040
    s_lshl_b32 s3, s84, 10
    s_add_u32 s85, s85, s3
    s_lshl_b32 s3, s83, 14
    s_add_u32 s86, s85, s3
    s_add_u32 s86, s86, 229376
    s_mul_i32 s3, s83, 57344
    s_add_u32 s85, s85, s3
    s_mul_i32 s3, s100, 14336
    s_add_u32 s85, s85, s3
    s_lshl_b32 s3, s79, 8
    s_lshl_b32 s26, s84, 7
    s_add_u32 s3, s3, s26
    s_add_u32 s21, s3, 14680064
    s_waitcnt vmcnt(2)
    s_barrier
    ds_read_b64_tr_b16 v[112:113], v20 offset:16384
    ds_read_b64_tr_b16 v[114:115], v20 offset:17408
    ds_read_b64_tr_b16 v[116:117], v21 offset:16384
    ds_read_b64_tr_b16 v[118:119], v21 offset:17408
    ds_read_b64_tr_b16 v[152:153], v20 offset:0
    ds_read_b64_tr_b16 v[154:155], v20 offset:1024
    ds_read_b64_tr_b16 v[156:157], v21 offset:0
    ds_read_b64_tr_b16 v[158:159], v21 offset:1024
    ds_read_b64_tr_b16 v[160:161], v20 offset:8192
    ds_read_b64_tr_b16 v[162:163], v20 offset:9216
    ds_read_b64_tr_b16 v[164:165], v21 offset:8192
    ds_read_b64_tr_b16 v[166:167], v21 offset:9216
    ds_read_b64_tr_b16 v[120:121], v16 offset:32768
    ds_read_b64_tr_b16 v[122:123], v16 offset:33792
    ds_read_b64_tr_b16 v[124:125], v17 offset:32768
    ds_read_b64_tr_b16 v[126:127], v17 offset:33792
    ds_read_b64_tr_b16 v[128:129], v16 offset:40960
    ds_read_b64_tr_b16 v[130:131], v16 offset:41984
    ds_read_b64_tr_b16 v[132:133], v17 offset:40960
    ds_read_b64_tr_b16 v[134:135], v17 offset:41984
    ds_read_b64_tr_b16 v[216:217], v16 offset:16384
    ds_read_b64_tr_b16 v[218:219], v16 offset:17408
    ds_read_b64_tr_b16 v[220:221], v17 offset:16384
    ds_read_b64_tr_b16 v[222:223], v17 offset:17408
    ds_read_b64_tr_b16 v[224:225], v16 offset:24576
    ds_read_b64_tr_b16 v[226:227], v16 offset:25600
    ds_read_b64_tr_b16 v[228:229], v17 offset:24576
    ds_read_b64_tr_b16 v[230:231], v17 offset:25600
    ds_read_b64_tr_b16 v[232:233], v18 offset:16384
    ds_read_b64_tr_b16 v[234:235], v18 offset:17408
    ds_read_b64_tr_b16 v[236:237], v19 offset:16384
    ds_read_b64_tr_b16 v[238:239], v19 offset:17408
    ds_read_b64_tr_b16 v[240:241], v18 offset:24576
    ds_read_b64_tr_b16 v[242:243], v18 offset:25600
    ds_read_b64_tr_b16 v[244:245], v19 offset:24576
    ds_read_b64_tr_b16 v[246:247], v19 offset:25600
    s_waitcnt lgkmcnt(0)
    s_barrier
    s_waitcnt vmcnt(0)
    s_mov_b64 exec, 1
    v_mov_b32 v4, 158720
    v_mov_b32 v5, 1
    ds_add_rtn_u32 v6, v4, v5 offset:8
    s_waitcnt lgkmcnt(0)
    v_cmp_eq_u32 vcc, 3, v6
    s_cbranch_vccz F_KF1
    buffer_store_dwordx2 v[22:23], v7, s[36:39], s77 offen sc1
F_KF1:
    s_mov_b64 exec, -1
    ds_read_b64_tr_b16 v[168:169], v16 offset:0
    ds_read_b64_tr_b16 v[170:171], v16 offset:1024
    ds_read_b64_tr_b16 v[172:173], v17 offset:0
    ds_read_b64_tr_b16 v[174:175], v17 offset:1024
    ds_read_b64_tr_b16 v[176:177], v16 offset:8192
    ds_read_b64_tr_b16 v[178:179], v16 offset:9216
    ds_read_b64_tr_b16 v[180:181], v17 offset:8192
    ds_read_b64_tr_b16 v[182:183], v17 offset:9216
    ds_read_b64_tr_b16 v[184:185], v16 offset:49152
    ds_read_b64_tr_b16 v[186:187], v16 offset:50176
    ds_read_b64_tr_b16 v[188:189], v17 offset:49152
    ds_read_b64_tr_b16 v[190:191], v17 offset:50176
    ds_read_b64_tr_b16 v[192:193], v16 offset:57344
    ds_read_b64_tr_b16 v[194:195], v16 offset:58368
    ds_read_b64_tr_b16 v[196:197], v17 offset:57344
    ds_read_b64_tr_b16 v[198:199], v17 offset:58368
    ds_read_b64_tr_b16 v[200:201], v18 offset:0
    ds_read_b64_tr_b16 v[202:203], v18 offset:1024
    ds_read_b64_tr_b16 v[204:205], v19 offset:0
    ds_read_b64_tr_b16 v[206:207], v19 offset:1024
    ds_read_b64_tr_b16 v[208:209], v18 offset:8192
    ds_read_b64_tr_b16 v[210:211], v18 offset:9216
    ds_read_b64_tr_b16 v[212:213], v19 offset:8192
    ds_read_b64_tr_b16 v[214:215], v19 offset:9216
    s_barrier
    ds_read_b64_tr_b16 v[136:137], v18 offset:49152
    ds_read_b64_tr_b16 v[138:139], v18 offset:50176
    ds_read_b64_tr_b16 v[140:141], v19 offset:49152
    ds_read_b64_tr_b16 v[142:143], v19 offset:50176
    ds_read_b64_tr_b16 v[144:145], v18 offset:57344
    ds_read_b64_tr_b16 v[146:147], v18 offset:58368
    ds_read_b64_tr_b16 v[148:149], v19 offset:57344
    ds_read_b64_tr_b16 v[150:151], v19 offset:58368
    ds_read_b64_tr_b16 v[248:249], v18 offset:32768
    ds_read_b64_tr_b16 v[250:251], v18 offset:33792
    ds_read_b64_tr_b16 v[252:253], v19 offset:32768
    ds_read_b64_tr_b16 v[254:255], v19 offset:33792
    buffer_load_dwordx2 v[38:39], v11, s[36:39], s70 offen sc1
    s_waitcnt lgkmcnt(0)
    s_barrier
    s_mov_b32 s88, 0
    s_waitcnt vmcnt(0)
F_MAIN:
    s_mov_b32 s87, 0
F_PH_S:
    v_cmp_ne_u64 vcc, v[22:23], v[38:39]
    s_cbranch_vccz F_PH_G
    s_add_u32 s87, s87, 1
    s_cmp_ge_u32 s87, 0x10000
    s_cbranch_scc1 F_PH_G
    s_sleep 8
    buffer_load_dwordx2 v[38:39], v11, s[36:39], s70 offen sc1
    s_waitcnt vmcnt(0)
    s_branch F_PH_S
F_PH_G:
    buffer_load_dwordx4 v[40:43], v12, s[36:39], s85 offen offset:0 sc1
    buffer_load_dwordx4 v[44:47], v12, s[36:39], s85 offen offset:2048 sc1
    s_add_u32 s85, s85, 4096
    buffer_load_dwordx4 v[48:51], v12, s[36:39], s85 offen offset:0 sc1
    buffer_load_dwordx4 v[52:55], v12, s[36:39], s85 offen offset:2048 sc1
    s_add_u32 s85, s85, 4096
    s_waitcnt vmcnt(3)
    v_mfma_f32_32x32x16_bf16 v[80:95], v[112:115], v[40:43], 0
    v_mfma_f32_32x32x16_bf16 v[96:111], v[116:119], v[40:43], 0
    buffer_load_dwordx4 v[40:43], v12, s[36:39], s85 offen offset:0 sc1
    s_lshl_b32 s3, s60, 2
    s_add_u32 s3, s3, 158752
    v_mov_b32 v5, s3
    v_mov_b32 v4, 1
    ds_write_b32 v5, v4
    v_xor_b32 v37, 16, v5
    s_cmp_eq_u32 s88, 2
    s_cbranch_scc0 F_NL
    v_mov_b32 v37, v5
F_NL:
    s_waitcnt vmcnt(3)
    v_mfma_f32_32x32x16_bf16 v[80:95], v[120:123], v[44:47], v[80:95]
    v_mfma_f32_32x32x16_bf16 v[96:111], v[124:127], v[44:47], v[96:111]
    buffer_load_dwordx4 v[44:47], v12, s[36:39], s85 offen offset:2048 sc1
    s_add_u32 s85, s85, 4096
    s_waitcnt vmcnt(3)
    v_mfma_f32_32x32x16_bf16 v[80:95], v[128:131], v[48:51], v[80:95]
    v_mfma_f32_32x32x16_bf16 v[96:111], v[132:135], v[48:51], v[96:111]
    buffer_load_dwordx4 v[48:51], v12, s[36:39], s85 offen offset:0 sc1
    s_waitcnt vmcnt(3)
    v_mfma_f32_32x32x16_bf16 v[80:95], v[136:139], v[52:55], v[80:95]
    v_mfma_f32_32x32x16_bf16 v[96:111], v[140:143], v[52:55], v[96:111]
    s_cmp_eq_u32 s100, 3
    s_cselect_b32 s3, 57344, 0
    s_sub_u32 s85, s85, s3
    buffer_load_dwordx4 v[52:55], v12, s[36:39], s85 offen offset:2048 sc1
    s_add_u32 s85, s85, 4096
    s_waitcnt vmcnt(3)
    v_mfma_f32_32x32x16_bf16 v[80:95], v[144:147], v[40:43], v[80:95]
    v_mfma_f32_32x32x16_bf16 v[96:111], v[148:151], v[40:43], v[96:111]
    buffer_load_dwordx4 v[40:43], v12, s[36:39], s85 offen offset:0 sc1
    s_branch F_MJ
F_MAINC:
    s_waitcnt vmcnt(7)
    s_nop 5
    v_mfma_f32_32x32x16_bf16 v[80:95], v[112:115], v[40:43], 0
    v_mfma_f32_32x32x16_bf16 v[96:111], v[116:119], v[40:43], 0
    buffer_load_dwordx4 v[40:43], v12, s[36:39], s85 offen offset:0 sc1
    s_lshl_b32 s3, s60, 2
    s_add_u32 s3, s3, 158752
    v_mov_b32 v5, s3
    v_mov_b32 v4, 1
    ds_write_b32 v5, v4
    v_xor_b32 v37, 16, v5
    s_waitcnt vmcnt(7)
    v_mfma_f32_32x32x16_bf16 v[80:95], v[120:123], v[44:47], v[80:95]
    v_mfma_f32_32x32x16_bf16 v[96:111], v[124:127], v[44:47], v[96:111]
    buffer_load_dwordx4 v[44:47], v12, s[36:39], s85 offen offset:2048 sc1
    s_add_u32 s85, s85, 4096
    s_waitcnt vmcnt(7)
    v_mfma_f32_32x32x16_bf16 v[80:95], v[128:131], v[48:51], v[80:95]
    v_mfma_f32_32x32x16_bf16 v[96:111], v[132:135], v[48:51], v[96:111]
    buffer_load_dwordx4 v[48:51], v12, s[36:39], s85 offen offset:0 sc1
    s_waitcnt vmcnt(7)
    v_mfma_f32_32x32x16_bf16 v[80:95], v[136:139], v[52:55], v[80:95]
    v_mfma_f32_32x32x16_bf16 v[96:111], v[140:143], v[52:55], v[96:111]
    s_cmp_eq_u32 s100, 3
    s_cselect_b32 s3, 57344, 0
    s_sub_u32 s85, s85, s3
    buffer_load_dwordx4 v[52:55], v12, s[36:39], s85 offen offset:2048 sc1
    s_add_u32 s85, s85, 4096
    s_waitcnt vmcnt(3)
    v_mfma_f32_32x32x16_bf16 v[80:95], v[144:147], v[40:43], v[80:95]
    v_mfma_f32_32x32x16_bf16 v[96:111], v[148:151], v[40:43], v[96:111]
    buffer_load_dwordx4 v[40:43], v12, s[36:39], s85 offen offset:0 sc1
    s_mov_b64 exec, 1
    v_mov_b32 v4, 158720
    v_mov_b32 v5, 1
    ds_add_rtn_u32 v6, v4, v5 offset:4
    s_waitcnt lgkmcnt(0)
    v_cmp_eq_u32 vcc, 3, v6
    s_cbranch_vccz F_HF2
    buffer_store_dwordx2 v[22:23], v7, s[36:39], s78 offen sc1
F_HF2:
    s_mov_b64 exec, -1
F_MJ:
    s_waitcnt vmcnt(3)
    v_mfma_f32_32x32x16_bf16 v[80:95], v[152:155], v[44:47], v[80:95]
    v_mfma_f32_32x32x16_bf16 v[96:111], v[156:159], v[44:47], v[96:111]
    buffer_load_dwordx4 v[44:47], v12, s[36:39], s85 offen offset:2048 sc1
    s_add_u32 s85, s85, 4096
    s_waitcnt vmcnt(3)
    v_mfma_f32_32x32x16_bf16 v[80:95], v[160:163], v[48:51], v[80:95]
    v_mfma_f32_32x32x16_bf16 v[96:111], v[164:167], v[48:51], v[96:111]
    buffer_load_dwordx4 v[48:51], v12, s[36:39], s85 offen offset:0 sc1
    s_waitcnt vmcnt(3)
    v_mfma_f32_32x32x16_bf16 v[80:95], v[168:171], v[52:55], v[80:95]
    v_mfma_f32_32x32x16_bf16 v[96:111], v[172:175], v[52:55], v[96:111]
    buffer_load_dwordx4 v[52:55], v12, s[36:39], s85 offen offset:2048 sc1
    s_add_u32 s85, s85, 4096
    s_waitcnt vmcnt(3)
    v_mfma_f32_32x32x16_bf16 v[80:95], v[176:179], v[40:43], v[80:95]
    v_mfma_f32_32x32x16_bf16 v[96:111], v[180:183], v[40:43], v[96:111]
    buffer_load_dwordx4 v[40:43], v12, s[36:39], s85 offen offset:0 sc1
    s_waitcnt vmcnt(3)
    v_mfma_f32_32x32x16_bf16 v[80:95], v[184:187], v[44:47], v[80:95]
    v_mfma_f32_32x32x16_bf16 v[96:111], v[188:191], v[44:47], v[96:111]
    buffer_load_dwordx4 v[44:47], v12, s[36:39], s85 offen offset:2048 sc1
    s_add_u32 s85, s85, 4096
    s_waitcnt vmcnt(3)
    v_mfma_f32_32x32x16_bf16 v[80:95], v[192:195], v[48:51], v[80:95]
    v_mfma_f32_32x32x16_bf16 v[96:111], v[196:199], v[48:51], v[96:111]
    s_cmp_eq_u32 s100, 2
    s_cselect_b32 s3, 57344, 0
    s_sub_u32 s85, s85, s3
    buffer_load_dwordx4 v[48:51], v12, s[36:39], s85 offen offset:0 sc1
    s_waitcnt vmcnt(3)
    v_mfma_f32_32x32x16_bf16 v[80:95], v[200:203], v[52:55], v[80:95]
    v_mfma_f32_32x32x16_bf16 v[96:111], v[204:207], v[52:55], v[96:111]
    buffer_load_dwordx4 v[52:55], v12, s[36:39], s85 offen offset:2048 sc1
    s_add_u32 s85, s85, 4096
    s_waitcnt vmcnt(3)
    v_mfma_f32_32x32x16_bf16 v[80:95], v[208:211], v[40:43], v[80:95]
    v_mfma_f32_32x32x16_bf16 v[96:111], v[212:215], v[40:43], v[96:111]
    buffer_load_dwordx4 v[40:43], v12, s[36:39], s85 offen offset:0 sc1
    s_waitcnt vmcnt(3)
    v_mfma_f32_32x32x16_bf16 v[80:95], v[216:219], v[44:47], v[80:95]
    v_mfma_f32_32x32x16_bf16 v[96:111], v[220:223], v[44:47], v[96:111]
    buffer_load_dwordx4 v[44:47], v12, s[36:39], s85 offen offset:2048 sc1
    s_add_u32 s85, s85, 4096
    s_waitcnt vmcnt(3)
    v_mfma_f32_32x32x16_bf16 v[80:95], v[224:227], v[48:51], v[80:95]
    v_mfma_f32_32x32x16_bf16 v[96:111], v[228:231], v[48:51], v[96:111]
    buffer_load_dwordx4 v[48:51], v12, s[36:39], s85 offen offset:0 sc1
    s_waitcnt vmcnt(3)
    v_mfma_f32_32x32x16_bf16 v[80:95], v[232:235], v[52:55], v[80:95]
    v_mfma_f32_32x32x16_bf16 v[96:111], v[236:239], v[52:55], v[96:111]
    buffer_load_dwordx4 v[52:55], v12, s[36:39], s85 offen offset:2048 sc1
    s_add_u32 s85, s85, 4096
    s_waitcnt vmcnt(3)
    v_mfma_f32_32x32x16_bf16 v[80:95], v[240:243], v[40:43], v[80:95]
    v_mfma_f32_32x32x16_bf16 v[96:111], v[244:247], v[40:43], v[96:111]
    buffer_load_dwordx4 v[40:43], v12, s[36:39], s85 offen offset:0 sc1
    s_mov_b32 s87, 0
F_W2_S:
    ds_read_b32 v4, v37
    s_waitcnt lgkmcnt(0)
    v_cmp_eq_u32 vcc, 0, v4
    s_cbranch_vccz F_W2_G
    s_add_u32 s87, s87, 1
    s_cmp_ge_u32 s87, 0x400000
    s_cbranch_scc1 F_W2_G
    s_sleep 1
    s_branch F_W2_S
F_W2_G:
    ds_read_b64_tr_b16 v[112:113], v20 offset:16384
    ds_read_b64_tr_b16 v[114:115], v20 offset:17408
    ds_read_b64_tr_b16 v[116:117], v21 offset:16384
    ds_read_b64_tr_b16 v[118:119], v21 offset:17408
    s_waitcnt vmcnt(3)
    v_mfma_f32_32x32x16_bf16 v[80:95], v[248:251], v[44:47], v[80:95]
    v_mfma_f32_32x32x16_bf16 v[96:111], v[252:255], v[44:47], v[96:111]
    buffer_load_dwordx2 v[38:39], v13, s[36:39], s19 offen sc1
    s_cmp_eq_u32 s100, 1
    s_cselect_b32 s3, 57344, 0
    s_sub_u32 s85, s85, s3
    buffer_load_dwordx4 v[44:47], v12, s[36:39], s85 offen offset:2048 sc1
    s_add_u32 s85, s85, 4096
    ds_read_b64_tr_b16 v[120:121], v16 offset:32768
    ds_read_b64_tr_b16 v[122:123], v16 offset:33792
    ds_read_b64_tr_b16 v[124:125], v17 offset:32768
    ds_read_b64_tr_b16 v[126:127], v17 offset:33792
    s_waitcnt vmcnt(4)
    s_waitcnt lgkmcnt(4)
    v_mfma_f32_32x32x16_bf16 v[80:95], v[112:115], v[48:51], v[80:95]
    v_mfma_f32_32x32x16_bf16 v[96:111], v[116:119], v[48:51], v[96:111]
    buffer_load_dwordx4 v[48:51], v12, s[36:39], s85 offen offset:0 sc1
    ds_read_b64_tr_b16 v[112:113], v16 offset:40960
    ds_read_b64_tr_b16 v[114:115], v16 offset:41984
    ds_read_b64_tr_b16 v[116:117], v17 offset:40960
    ds_read_b64_tr_b16 v[118:119], v17 offset:41984
    s_waitcnt vmcnt(4)
    s_waitcnt lgkmcnt(4)
    v_mfma_f32_32x32x16_bf16 v[80:95], v[120:123], v[52:55], v[80:95]
    v_mfma_f32_32x32x16_bf16 v[96:111], v[124:127], v[52:55], v[96:111]
    buffer_load_dwordx4 v[52:55], v12, s[36:39], s85 offen offset:2048 sc1
    s_add_u32 s85, s85, 4096
    ds_read_b64_tr_b16 v[120:121], v18 offset:49152
    ds_read_b64_tr_b16 v[122:123], v18 offset:50176
    ds_read_b64_tr_b16 v[124:125], v19 offset:49152
    ds_read_b64_tr_b16 v[126:127], v19 offset:50176
    s_waitcnt vmcnt(4)
    s_waitcnt lgkmcnt(4)
    v_mfma_f32_32x32x16_bf16 v[80:95], v[112:115], v[40:43], v[80:95]
    v_mfma_f32_32x32x16_bf16 v[96:111], v[116:119], v[40:43], v[96:111]
    s_waitcnt vmcnt(3)
    v_cmp_ne_u64 vcc, v[22:23], v[38:39]
    s_nop 0
    s_mov_b32 s89, vcc_lo
    s_and_b32 s3, vcc_lo, 12
    s_cbranch_scc0 F_PX_G
    buffer_load_dwordx2 v[38:39], v10, s[36:39], s19 offen sc1
    s_waitcnt vmcnt(0)
    s_mov_b32 s87, 0
F_PX_S:
    v_cmp_ne_u64 vcc, v[22:23], v[38:39]
    s_cbranch_vccz F_PX_G
    s_add_u32 s87, s87, 1
    s_cmp_ge_u32 s87, 0x10000
    s_cbranch_scc1 F_PX_G
    s_sleep 2
    buffer_load_dwordx2 v[38:39], v10, s[36:39], s19 offen sc1
    s_waitcnt vmcnt(0)
    s_branch F_PX_S
F_PX_G:
    buffer_load_dwordx4 v[40:43], v12, s[36:39], s85 offen offset:0 sc1
    ds_read_b64_tr_b16 v[112:113], v18 offset:57344
    ds_read_b64_tr_b16 v[114:115], v18 offset:58368
    ds_read_b64_tr_b16 v[116:117], v19 offset:57344
    ds_read_b64_tr_b16 v[118:119], v19 offset:58368
    s_waitcnt vmcnt(3)
    s_waitcnt lgkmcnt(4)
    v_mfma_f32_32x32x16_bf16 v[80:95], v[120:123], v[44:47], v[80:95]
    v_mfma_f32_32x32x16_bf16 v[96:111], v[124:127], v[44:47], v[96:111]
    buffer_load_dwordx4 v[44:47], v12, s[36:39], s85 offen offset:2048 sc1
    s_add_u32 s85, s85, 4096
    s_cmp_eq_u32 s89, 0
    s_cbranch_scc1 F_NPO
    buffer_load_dwordx2 v[38:39], v13, s[36:39], s19 offen sc1
F_NPO:
    ds_read_b64_tr_b16 v[120:121], v20 offset:0
    ds_read_b64_tr_b16 v[122:123], v20 offset:1024
    ds_read_b64_tr_b16 v[124:125], v21 offset:0
    ds_read_b64_tr_b16 v[126:127], v21 offset:1024
    s_waitcnt vmcnt(3)
    s_waitcnt lgkmcnt(4)
    v_mfma_f32_32x32x16_bf16 v[80:95], v[112:115], v[48:51], v[80:95]
    v_mfma_f32_32x32x16_bf16 v[96:111], v[116:119], v[48:51], v[96:111]
    buffer_load_dwordx4 v[48:51], v12, s[36:39], s85 offen offset:0 sc1
    ds_read_b64_tr_b16 v[112:113], v20 offset:8192
    ds_read_b64_tr_b16 v[114:115], v20 offset:9216
    ds_read_b64_tr_b16 v[116:117], v21 offset:8192
    ds_read_b64_tr_b16 v[118:119], v21 offset:9216
    s_waitcnt vmcnt(3)
    s_waitcnt lgkmcnt(4)
    v_mfma_f32_32x32x16_bf16 v[80:95], v[120:123], v[52:55], v[80:95]
    v_mfma_f32_32x32x16_bf16 v[96:111], v[124:127], v[52:55], v[96:111]
    buffer_load_dwordx4 v[52:55], v12, s[36:39], s85 offen offset:2048 sc1
    s_add_u32 s85, s85, 4096
    ds_read_b64_tr_b16 v[120:121], v16 offset:0
    ds_read_b64_tr_b16 v[122:123], v16 offset:1024
    ds_read_b64_tr_b16 v[124:125], v17 offset:0
    ds_read_b64_tr_b16 v[126:127], v17 offset:1024
    s_waitcnt vmcnt(3)
    s_waitcnt lgkmcnt(4)
    v_mfma_f32_32x32x16_bf16 v[80:95], v[112:115], v[40:43], v[80:95]
    v_mfma_f32_32x32x16_bf16 v[96:111], v[116:119], v[40:43], v[96:111]
    s_cmp_eq_u32 s89, 0
    s_cbranch_scc1 F_FAST
    s_waitcnt vmcnt(2)
    v_cmp_ne_u64 vcc, v[22:23], v[38:39]
    s_cbranch_vccnz F_SLOW
F_FAST:
    buffer_load_dword v36, v1, s[36:39], s21 offen sc1
    buffer_load_dwordx4 v[40:43], v12, s[36:39], s86 offen offset:0 sc1
    ds_read_b64_tr_b16 v[112:113], v16 offset:8192
    ds_read_b64_tr_b16 v[114:115], v16 offset:9216
    ds_read_b64_tr_b16 v[116:117], v17 offset:8192
    ds_read_b64_tr_b16 v[118:119], v17 offset:9216
    s_waitcnt vmcnt(4)
    s_waitcnt lgkmcnt(4)
    v_mfma_f32_32x32x16_bf16 v[80:95], v[120:123], v[44:47], v[80:95]
    v_mfma_f32_32x32x16_bf16 v[96:111], v[124:127], v[44:47], v[96:111]
    buffer_load_dwordx4 v[44:47], v12, s[36:39], s86 offen offset:2048 sc1
    s_add_u32 s86, s86, 4096
    ds_read_b64_tr_b16 v[120:121], v16 offset:49152
    ds_read_b64_tr_b16 v[122:123], v16 offset:50176
    ds_read_b64_tr_b16 v[124:125], v17 offset:49152
    ds_read_b64_tr_b16 v[126:127], v17 offset:50176
    s_waitcnt vmcnt(4)
    s_waitcnt lgkmcnt(4)
    v_mfma_f32_32x32x16_bf16 v[80:95], v[112:115], v[48:51], v[80:95]
    v_mfma_f32_32x32x16_bf16 v[96:111], v[116:119], v[48:51], v[96:111]
    buffer_load_dwordx4 v[48:51], v12, s[36:39], s86 offen offset:0 sc1
    ds_read_b64_tr_b16 v[112:113], v16 offset:57344
    ds_read_b64_tr_b16 v[114:115], v16 offset:58368
    ds_read_b64_tr_b16 v[116:117], v17 offset:57344
    ds_read_b64_tr_b16 v[118:119], v17 offset:58368
    s_waitcnt vmcnt(4)
    s_waitcnt lgkmcnt(4)
    v_mfma_f32_32x32x16_bf16 v[80:95], v[120:123], v[52:55], v[80:95]
    v_mfma_f32_32x32x16_bf16 v[96:111], v[124:127], v[52:55], v[96:111]
    buffer_load_dwordx4 v[52:55], v12, s[36:39], s86 offen offset:2048 sc1
    s_add_u32 s86, s86, 4096
    ds_read_b64_tr_b16 v[120:121], v18 offset:0
    ds_read_b64_tr_b16 v[122:123], v18 offset:1024
    ds_read_b64_tr_b16 v[124:125], v19 offset:0
    ds_read_b64_tr_b16 v[126:127], v19 offset:1024
    s_waitcnt vmcnt(3)
    s_waitcnt lgkmcnt(4)
    v_mfma_f32_32x32x16_bf16 v[144:159], v[112:115], v[40:43], 0
    v_mfma_f32_32x32x16_bf16 v[160:175], v[116:119], v[40:43], 0
    buffer_load_dwordx4 v[40:43], v12, s[36:39], s86 offen offset:0 sc1
    ds_read_b64_tr_b16 v[112:113], v18 offset:8192
    ds_read_b64_tr_b16 v[114:115], v18 offset:9216
    ds_read_b64_tr_b16 v[116:117], v19 offset:8192
    ds_read_b64_tr_b16 v[118:119], v19 offset:9216
    s_waitcnt vmcnt(3)
    s_waitcnt lgkmcnt(4)
    v_mfma_f32_32x32x16_bf16 v[144:159], v[120:123], v[44:47], v[144:159]
    v_mfma_f32_32x32x16_bf16 v[160:175], v[124:127], v[44:47], v[160:175]
    buffer_load_dwordx4 v[44:47], v12, s[36:39], s86 offen offset:2048 sc1
    s_add_u32 s86, s86, 4096
    ds_read_b64_tr_b16 v[120:121], v16 offset:16384
    ds_read_b64_tr_b16 v[122:123], v16 offset:17408
    ds_read_b64_tr_b16 v[124:125], v17 offset:16384
    ds_read_b64_tr_b16 v[126:127], v17 offset:17408
    s_waitcnt vmcnt(3)
    s_waitcnt lgkmcnt(4)
    v_mfma_f32_32x32x16_bf16 v[144:159], v[112:115], v[48:51], v[144:159]
    v_mfma_f32_32x32x16_bf16 v[160:175], v[116:119], v[48:51], v[160:175]
    buffer_load_dwordx4 v[48:51], v12, s[36:39], s86 offen offset:0 sc1
    v_sub_f32 v4, 1.0, v36
    v_pk_mul_f32 v[80:81], v[80:81], v[4:5] op_sel_hi:[1,0]
    v_pk_mul_f32 v[82:83], v[82:83], v[4:5] op_sel_hi:[1,0]
    v_pk_mul_f32 v[84:85], v[84:85], v[4:5] op_sel_hi:[1,0]
    v_pk_mul_f32 v[86:87], v[86:87], v[4:5] op_sel_hi:[1,0]
    v_pk_mul_f32 v[88:89], v[88:89], v[4:5] op_sel_hi:[1,0]
    v_pk_mul_f32 v[90:91], v[90:91], v[4:5] op_sel_hi:[1,0]
    v_pk_mul_f32 v[92:93], v[92:93], v[4:5] op_sel_hi:[1,0]
    v_pk_mul_f32 v[94:95], v[94:95], v[4:5] op_sel_hi:[1,0]
    v_pk_mul_f32 v[96:97], v[96:97], v[4:5] op_sel_hi:[1,0]
    v_pk_mul_f32 v[98:99], v[98:99], v[4:5] op_sel_hi:[1,0]
    v_pk_mul_f32 v[100:101], v[100:101], v[4:5] op_sel_hi:[1,0]
    v_pk_mul_f32 v[102:103], v[102:103], v[4:5] op_sel_hi:[1,0]
    v_pk_mul_f32 v[104:105], v[104:105], v[4:5] op_sel_hi:[1,0]
    v_pk_mul_f32 v[106:107], v[106:107], v[4:5] op_sel_hi:[1,0]
    v_pk_mul_f32 v[108:109], v[108:109], v[4:5] op_sel_hi:[1,0]
    v_pk_mul_f32 v[110:111], v[110:111], v[4:5] op_sel_hi:[1,0]
    ds_read_b64_tr_b16 v[112:113], v16 offset:24576
    ds_read_b64_tr_b16 v[114:115], v16 offset:25600
    ds_read_b64_tr_b16 v[116:117], v17 offset:24576
    ds_read_b64_tr_b16 v[118:119], v17 offset:25600
    s_waitcnt vmcnt(3)
    s_waitcnt lgkmcnt(4)
    v_mfma_f32_32x32x16_bf16 v[144:159], v[120:123], v[52:55], v[144:159]
    v_mfma_f32_32x32x16_bf16 v[160:175], v[124:127], v[52:55], v[160:175]
    buffer_load_dwordx4 v[52:55], v12, s[36:39], s86 offen offset:2048 sc1
    s_add_u32 s86, s86, 4096
    ds_read_b64_tr_b16 v[120:121], v18 offset:16384
    ds_read_b64_tr_b16 v[122:123], v18 offset:17408
    ds_read_b64_tr_b16 v[124:125], v19 offset:16384
    ds_read_b64_tr_b16 v[126:127], v19 offset:17408
    s_waitcnt vmcnt(3)
    s_waitcnt lgkmcnt(4)
    v_mfma_f32_32x32x16_bf16 v[144:159], v[112:115], v[40:43], v[144:159]
    v_mfma_f32_32x32x16_bf16 v[160:175], v[116:119], v[40:43], v[160:175]
    s_mul_i32 s26, s60, 8704
    s_xor_b32 s3, s83, 0
    s_mul_i32 s3, s3, 2176
    s_add_u32 s3, s3, s26
    v_add_u32 v24, s3, v12
    s_xor_b32 s3, s83, 1
    s_mul_i32 s3, s3, 2176
    s_add_u32 s3, s3, s26
    v_add_u32 v25, s3, v12
    s_xor_b32 s3, s83, 2
    s_mul_i32 s3, s3, 2176
    s_add_u32 s3, s3, s26
    v_add_u32 v26, s3, v12
    s_xor_b32 s3, s83, 3
    s_mul_i32 s3, s3, 2176
    s_add_u32 s3, s3, s26
    v_add_u32 v27, s3, v12
    v_lshrrev_b32 v28, 3, v0
    s_lshl_b32 s3, s83, 3
    v_add_u32 v28, s3, v28
    v_and_b32 v29, 7, v0
    v_lshlrev_b32 v30, 10, v28
    v_lshl_add_u32 v30, v29, 4, v30
    v_lshlrev_b32 v28, 4, v28
    v_mul_u32_u24 v29, 1088, v29
    v_add_u32 v29, v29, v28
    s_mul_i32 s3, s84, 34816
    v_add_u32 v29, s3, v29
    s_lshl_b32 s3, s79, 16
    s_lshl_b32 s27, s84, 15
    s_add_u32 s3, s3, s27
    s_lshl_b32 s27, s80, 7
    s_add_u32 s21, s3, s27
    ds_read_b64_tr_b16 v[112:113], v18 offset:24576
    ds_read_b64_tr_b16 v[114:115], v18 offset:25600
    ds_read_b64_tr_b16 v[116:117], v19 offset:24576
    ds_read_b64_tr_b16 v[118:119], v19 offset:25600
    s_waitcnt vmcnt(2)
    s_waitcnt lgkmcnt(4)
    v_mfma_f32_32x32x16_bf16 v[144:159], v[120:123], v[44:47], v[144:159]
    v_mfma_f32_32x32x16_bf16 v[160:175], v[124:127], v[44:47], v[160:175]
    ds_read_b64_tr_b16 v[120:121], v18 offset:32768
    ds_read_b64_tr_b16 v[122:123], v18 offset:33792
    ds_read_b64_tr_b16 v[124:125], v19 offset:32768
    ds_read_b64_tr_b16 v[126:127], v19 offset:33792
    s_waitcnt vmcnt(1)
    s_waitcnt lgkmcnt(4)
    v_mfma_f32_32x32x16_bf16 v[144:159], v[112:115], v[48:51], v[144:159]
    v_mfma_f32_32x32x16_bf16 v[160:175], v[116:119], v[48:51], v[160:175]
    s_waitcnt vmcnt(0)
    s_waitcnt lgkmcnt(0)
    v_mfma_f32_32x32x16_bf16 v[144:159], v[120:123], v[52:55], v[144:159]
    v_mfma_f32_32x32x16_bf16 v[160:175], v[124:127], v[52:55], v[160:175]
    s_branch F_TAIL
F_SLOW:
    ds_read_b64_tr_b16 v[112:113], v16 offset:8192
    ds_read_b64_tr_b16 v[114:115], v16 offset:9216
    ds_read_b64_tr_b16 v[116:117], v17 offset:8192
    ds_read_b64_tr_b16 v[118:119], v17 offset:9216
    s_waitcnt vmcnt(2)
    s_waitcnt lgkmcnt(4)
    v_mfma_f32_32x32x16_bf16 v[80:95], v[120:123], v[44:47], v[80:95]
    v_mfma_f32_32x32x16_bf16 v[96:111], v[124:127], v[44:47], v[96:111]
    ds_read_b64_tr_b16 v[120:121], v16 offset:49152
    ds_read_b64_tr_b16 v[122:123], v16 offset:50176
    ds_read_b64_tr_b16 v[124:125], v17 offset:49152
    ds_read_b64_tr_b16 v[126:127], v17 offset:50176
    s_waitcnt vmcnt(1)
    s_waitcnt lgkmcnt(4)
    v_mfma_f32_32x32x16_bf16 v[80:95], v[112:115], v[48:51], v[80:95]
    v_mfma_f32_32x32x16_bf16 v[96:111], v[116:119], v[48:51], v[96:111]
    buffer_load_dwordx2 v[38:39], v13, s[36:39], s19 offen sc1
    ds_read_b64_tr_b16 v[112:113], v16 offset:57344
    ds_read_b64_tr_b16 v[114:115], v16 offset:58368
    ds_read_b64_tr_b16 v[116:117], v17 offset:57344
    ds_read_b64_tr_b16 v[118:119], v17 offset:58368
    s_waitcnt vmcnt(1)
    s_waitcnt lgkmcnt(4)
    v_mfma_f32_32x32x16_bf16 v[80:95], v[120:123], v[52:55], v[80:95]
    v_mfma_f32_32x32x16_bf16 v[96:111], v[124:127], v[52:55], v[96:111]
    s_waitcnt vmcnt(0)
    s_mov_b32 s87, 0
F_PO_S:
    v_cmp_ne_u64 vcc, v[22:23], v[38:39]
    s_cbranch_vccz F_PO_G
    s_add_u32 s87, s87, 1
    s_cmp_ge_u32 s87, 0x10000
    s_cbranch_scc1 F_PO_G
    s_sleep 2
    buffer_load_dwordx2 v[38:39], v13, s[36:39], s19 offen sc1
    s_waitcnt vmcnt(0)
    s_branch F_PO_S
F_PO_G:
    buffer_load_dword v36, v1, s[36:39], s21 offen sc1
    buffer_load_dwordx4 v[40:43], v12, s[36:39], s86 offen offset:0 sc1
    buffer_load_dwordx4 v[44:47], v12, s[36:39], s86 offen offset:2048 sc1
    s_add_u32 s86, s86, 4096
    buffer_load_dwordx4 v[48:51], v12, s[36:39], s86 offen offset:0 sc1
    buffer_load_dwordx4 v[52:55], v12, s[36:39], s86 offen offset:2048 sc1
    s_add_u32 s86, s86, 4096
    ds_read_b64_tr_b16 v[120:121], v18 offset:0
    ds_read_b64_tr_b16 v[122:123], v18 offset:1024
    ds_read_b64_tr_b16 v[124:125], v19 offset:0
    ds_read_b64_tr_b16 v[126:127], v19 offset:1024
    s_waitcnt vmcnt(3)
    s_waitcnt lgkmcnt(4)
    v_mfma_f32_32x32x16_bf16 v[144:159], v[112:115], v[40:43], 0
    v_mfma_f32_32x32x16_bf16 v[160:175], v[116:119], v[40:43], 0
    buffer_load_dwordx4 v[40:43], v12, s[36:39], s86 offen offset:0 sc1
    ds_read_b64_tr_b16 v[112:113], v18 offset:8192
    ds_read_b64_tr_b16 v[114:115], v18 offset:9216
    ds_read_b64_tr_b16 v[116:117], v19 offset:8192
    ds_read_b64_tr_b16 v[118:119], v19 offset:9216
    s_waitcnt vmcnt(3)
    s_waitcnt lgkmcnt(4)
    v_mfma_f32_32x32x16_bf16 v[144:159], v[120:123], v[44:47], v[144:159]
    v_mfma_f32_32x32x16_bf16 v[160:175], v[124:127], v[44:47], v[160:175]
    buffer_load_dwordx4 v[44:47], v12, s[36:39], s86 offen offset:2048 sc1
    s_add_u32 s86, s86, 4096
    ds_read_b64_tr_b16 v[120:121], v16 offset:16384
    ds_read_b64_tr_b16 v[122:123], v16 offset:17408
    ds_read_b64_tr_b16 v[124:125], v17 offset:16384
    ds_read_b64_tr_b16 v[126:127], v17 offset:17408
    s_waitcnt vmcnt(3)
    s_waitcnt lgkmcnt(4)
    v_mfma_f32_32x32x16_bf16 v[144:159], v[112:115], v[48:51], v[144:159]
    v_mfma_f32_32x32x16_bf16 v[160:175], v[116:119], v[48:51], v[160:175]
    buffer_load_dwordx4 v[48:51], v12, s[36:39], s86 offen offset:0 sc1
    v_sub_f32 v4, 1.0, v36
    v_pk_mul_f32 v[80:81], v[80:81], v[4:5] op_sel_hi:[1,0]
    v_pk_mul_f32 v[82:83], v[82:83], v[4:5] op_sel_hi:[1,0]
    v_pk_mul_f32 v[84:85], v[84:85], v[4:5] op_sel_hi:[1,0]
    v_pk_mul_f32 v[86:87], v[86:87], v[4:5] op_sel_hi:[1,0]
    v_pk_mul_f32 v[88:89], v[88:89], v[4:5] op_sel_hi:[1,0]
    v_pk_mul_f32 v[90:91], v[90:91], v[4:5] op_sel_hi:[1,0]
    v_pk_mul_f32 v[92:93], v[92:93], v[4:5] op_sel_hi:[1,0]
    v_pk_mul_f32 v[94:95], v[94:95], v[4:5] op_sel_hi:[1,0]
    v_pk_mul_f32 v[96:97], v[96:97], v[4:5] op_sel_hi:[1,0]
    v_pk_mul_f32 v[98:99], v[98:99], v[4:5] op_sel_hi:[1,0]
    v_pk_mul_f32 v[100:101], v[100:101], v[4:5] op_sel_hi:[1,0]
    v_pk_mul_f32 v[102:103], v[102:103], v[4:5] op_sel_hi:[1,0]
    v_pk_mul_f32 v[104:105], v[104:105], v[4:5] op_sel_hi:[1,0]
    v_pk_mul_f32 v[106:107], v[106:107], v[4:5] op_sel_hi:[1,0]
    v_pk_mul_f32 v[108:109], v[108:109], v[4:5] op_sel_hi:[1,0]
    v_pk_mul_f32 v[110:111], v[110:111], v[4:5] op_sel_hi:[1,0]
    ds_read_b64_tr_b16 v[112:113], v16 offset:24576
    ds_read_b64_tr_b16 v[114:115], v16 offset:25600
    ds_read_b64_tr_b16 v[116:117], v17 offset:24576
    ds_read_b64_tr_b16 v[118:119], v17 offset:25600
    s_waitcnt vmcnt(3)
    s_waitcnt lgkmcnt(4)
    v_mfma_f32_32x32x16_bf16 v[144:159], v[120:123], v[52:55], v[144:159]
    v_mfma_f32_32x32x16_bf16 v[160:175], v[124:127], v[52:55], v[160:175]
    buffer_load_dwordx4 v[52:55], v12, s[36:39], s86 offen offset:2048 sc1
    s_add_u32 s86, s86, 4096
    ds_read_b64_tr_b16 v[120:121], v18 offset:16384
    ds_read_b64_tr_b16 v[122:123], v18 offset:17408
    ds_read_b64_tr_b16 v[124:125], v19 offset:16384
    ds_read_b64_tr_b16 v[126:127], v19 offset:17408
    s_waitcnt vmcnt(3)
    s_waitcnt lgkmcnt(4)
    v_mfma_f32_32x32x16_bf16 v[144:159], v[112:115], v[40:43], v[144:159]
    v_mfma_f32_32x32x16_bf16 v[160:175], v[116:119], v[40:43], v[160:175]
    s_mul_i32 s26, s60, 8704
    s_xor_b32 s3, s83, 0
    s_mul_i32 s3, s3, 2176
    s_add_u32 s3, s3, s26
    v_add_u32 v24, s3, v12
    s_xor_b32 s3, s83, 1
    s_mul_i32 s3, s3, 2176
    s_add_u32 s3, s3, s26
    v_add_u32 v25, s3, v12
    s_xor_b32 s3, s83, 2
    s_mul_i32 s3, s3, 2176
    s_add_u32 s3, s3, s26
    v_add_u32 v26, s3, v12
    s_xor_b32 s3, s83, 3
    s_mul_i32 s3, s3, 2176
    s_add_u32 s3, s3, s26
    v_add_u32 v27, s3, v12
    v_lshrrev_b32 v28, 3, v0
    s_lshl_b32 s3, s83, 3
    v_add_u32 v28, s3, v28
    v_and_b32 v29, 7, v0
    v_lshlrev_b32 v30, 10, v28
    v_lshl_add_u32 v30, v29, 4, v30
    v_lshlrev_b32 v28, 4, v28
    v_mul_u32_u24 v29, 1088, v29
    v_add_u32 v29, v29, v28
    s_mul_i32 s3, s84, 34816
    v_add_u32 v29, s3, v29
    s_lshl_b32 s3, s79, 16
    s_lshl_b32 s27, s84, 15
    s_add_u32 s3, s3, s27
    s_lshl_b32 s27, s80, 7
    s_add_u32 s21, s3, s27
    ds_read_b64_tr_b16 v[112:113], v18 offset:24576
    ds_read_b64_tr_b16 v[114:115], v18 offset:25600
    ds_read_b64_tr_b16 v[116:117], v19 offset:24576
    ds_read_b64_tr_b16 v[118:119], v19 offset:25600
    s_waitcnt vmcnt(2)
    s_waitcnt lgkmcnt(4)
    v_mfma_f32_32x32x16_bf16 v[144:159], v[120:123], v[44:47], v[144:159]
    v_mfma_f32_32x32x16_bf16 v[160:175], v[124:127], v[44:47], v[160:175]
    ds_read_b64_tr_b16 v[120:121], v18 offset:32768
    ds_read_b64_tr_b16 v[122:123], v18 offset:33792
    ds_read_b64_tr_b16 v[124:125], v19 offset:32768
    ds_read_b64_tr_b16 v[126:127], v19 offset:33792
    s_waitcnt vmcnt(1)
    s_waitcnt lgkmcnt(4)
    v_mfma_f32_32x32x16_bf16 v[144:159], v[112:115], v[48:51], v[144:159]
    v_mfma_f32_32x32x16_bf16 v[160:175], v[116:119], v[48:51], v[160:175]
    s_waitcnt vmcnt(0)
    s_waitcnt lgkmcnt(0)
    v_mfma_f32_32x32x16_bf16 v[144:159], v[120:123], v[52:55], v[144:159]
    v_mfma_f32_32x32x16_bf16 v[160:175], v[124:127], v[52:55], v[160:175]
F_TAIL:
    s_nop 7
    s_nop 3
    s_barrier
    v_pk_fma_f32 v[80:81], v[144:145], v[36:37], v[80:81] op_sel_hi:[1,0,1]
    v_pk_fma_f32 v[82:83], v[146:147], v[36:37], v[82:83] op_sel_hi:[1,0,1]
    v_pk_fma_f32 v[84:85], v[148:149], v[36:37], v[84:85] op_sel_hi:[1,0,1]
    v_pk_fma_f32 v[86:87], v[150:151], v[36:37], v[86:87] op_sel_hi:[1,0,1]
    ds_write_b128 v24, v[80:83] offset:0
    ds_write_b128 v24, v[84:87] offset:1088
    v_pk_fma_f32 v[88:89], v[152:153], v[36:37], v[88:89] op_sel_hi:[1,0,1]
    v_pk_fma_f32 v[90:91], v[154:155], v[36:37], v[90:91] op_sel_hi:[1,0,1]
    v_pk_fma_f32 v[92:93], v[156:157], v[36:37], v[92:93] op_sel_hi:[1,0,1]
    v_pk_fma_f32 v[94:95], v[158:159], v[36:37], v[94:95] op_sel_hi:[1,0,1]
    ds_write_b128 v25, v[88:91] offset:0
    ds_write_b128 v25, v[92:95] offset:1088
    v_pk_fma_f32 v[96:97], v[160:161], v[36:37], v[96:97] op_sel_hi:[1,0,1]
    v_pk_fma_f32 v[98:99], v[162:163], v[36:37], v[98:99] op_sel_hi:[1,0,1]
    v_pk_fma_f32 v[100:101], v[164:165], v[36:37], v[100:101] op_sel_hi:[1,0,1]
    v_pk_fma_f32 v[102:103], v[166:167], v[36:37], v[102:103] op_sel_hi:[1,0,1]
    ds_write_b128 v26, v[96:99] offset:0
    ds_write_b128 v26, v[100:103] offset:1088
    v_pk_fma_f32 v[104:105], v[168:169], v[36:37], v[104:105] op_sel_hi:[1,0,1]
    v_pk_fma_f32 v[106:107], v[170:171], v[36:37], v[106:107] op_sel_hi:[1,0,1]
    v_pk_fma_f32 v[108:109], v[172:173], v[36:37], v[108:109] op_sel_hi:[1,0,1]
    v_pk_fma_f32 v[110:111], v[174:175], v[36:37], v[110:111] op_sel_hi:[1,0,1]
    ds_write_b128 v27, v[104:107] offset:0
    ds_write_b128 v27, v[108:111] offset:1088
    s_mov_b32 s3, s21
    v_mov_b32 v6, v30
    s_waitcnt lgkmcnt(0)
    s_barrier
    ds_read_b128 v[40:43], v29 offset:0
    ds_read_b128 v[44:47], v29 offset:512
    ds_read_b128 v[48:51], v29 offset:8704
    ds_read_b128 v[52:55], v29 offset:9216
    ds_read_b128 v[56:59], v29 offset:17408
    ds_read_b128 v[60:63], v29 offset:17920
    ds_read_b128 v[64:67], v29 offset:26112
    ds_read_b128 v[68:71], v29 offset:26624
    s_waitcnt lgkmcnt(4)
    v_pk_add_f32 v[40:41], v[40:41], v[48:49]
    v_pk_add_f32 v[42:43], v[42:43], v[50:51]
    v_pk_add_f32 v[44:45], v[44:45], v[52:53]
    v_pk_add_f32 v[46:47], v[46:47], v[54:55]
    s_waitcnt lgkmcnt(2)
    v_pk_add_f32 v[40:41], v[40:41], v[56:57]
    v_pk_add_f32 v[42:43], v[42:43], v[58:59]
    v_pk_add_f32 v[44:45], v[44:45], v[60:61]
    v_pk_add_f32 v[46:47], v[46:47], v[62:63]
    s_waitcnt lgkmcnt(0)
    v_pk_add_f32 v[40:41], v[40:41], v[64:65]
    v_pk_add_f32 v[42:43], v[42:43], v[66:67]
    v_pk_add_f32 v[44:45], v[44:45], v[68:69]
    v_pk_add_f32 v[46:47], v[46:47], v[70:71]
    v_cvt_pk_bf16_f32 v24, v40, v41
    v_cvt_pk_bf16_f32 v25, v42, v43
    v_cvt_pk_bf16_f32 v26, v44, v45
    v_cvt_pk_bf16_f32 v27, v46, v47
    buffer_store_dwordx4 v[24:27], v6, s[52:55], s3 offen sc1
F_END:
    s_endpgm
F_CODE_END:
.section .rodata,"a"
.p2align 6
.amdhsa_kernel gated_mix__linear_kernel_hedgehog__dense_activation_relu__prompt_kernel
  .amdhsa_next_free_vgpr 256
  .amdhsa_next_free_sgpr 102
  .amdhsa_accum_offset 256
  .amdhsa_group_segment_fixed_size 0
  .amdhsa_kernarg_size 88
  .amdhsa_user_sgpr_count 2
  .amdhsa_user_sgpr_kernarg_segment_ptr 1
  .amdhsa_system_sgpr_workgroup_id_x 1
.end_amdhsa_kernel
```
